```python
import torch

def _softmax(x, axis=-1):
    return torch.softmax(x, dim=axis)
def _gelu(x):
    return torch.nn.functional.gelu(x, approximate="tanh")
def _silu(x):
    return torch.nn.functional.silu(x)
def _sigmoid(x):
    return torch.sigmoid(x)
def _layernorm(x, axis=-1, eps=1e-5):
    m = x.mean(dim=axis, keepdim=True)
    v = x.var(dim=axis, keepdim=True, unbiased=False)
    return (x - m) / torch.sqrt(v + eps)
def _scatter_add(tgt, idx, src, axis=0):
    return tgt.clone().index_add_(axis, idx, src)
def _segment_sum(src, seg, n):
    out = torch.zeros((n,) + src.shape[1:], dtype=src.dtype)
    return out.index_add_(0, seg, src)
def _pad(x, pw):
    flat = tuple(v for pair in reversed(pw) for v in pair)
    return torch.nn.functional.pad(x, flat)

kernel_name = 'standalone__mpnn_edge_mlp__graph'

def setup_inputs():

    _w = (lambda a: (lambda t: t.to(torch.bfloat16) if t.is_floating_point() else t)(torch.as_tensor(a)))
    N, deg, D, De = 25000, 32, 64, max(0, 1)
    E = N * deg
    return {
        "x": _w((lambda *s: torch.randn(*s, dtype=torch.bfloat16) * 0.05)(N, D)),
        "e_attr": _w((lambda *s: torch.randn(*s, dtype=torch.bfloat16) * 0.4)(E, De)),
        "src": _w((lambda lo, hi, *s: torch.randint(lo, hi, s))(0, N, E).to(torch.int64)),
        "dst": _w((lambda lo, hi, *s: torch.randint(lo, hi, s))(0, N, E).to(torch.int64)),
        "w_msg": _w((lambda *s: torch.randn(*s, dtype=torch.bfloat16) * 0.4)(2 * D + De, D)),
        "w_upd": _w((lambda *s: torch.randn(*s, dtype=torch.bfloat16) * 0.05)(2 * D, D)),
    }

def reference(x, e_attr, src, dst, w_msg, w_upd):
    N, D = x.shape
    m_in = torch.concatenate([x[src], x[dst], e_attr], axis=-1)
    msg = _silu(m_in @ w_msg)
    agg = _segment_sum(msg, dst, N)
    return _silu(torch.concatenate([x, agg], axis=-1) @ w_upd)
```

```asm
; @launch kernel=mpnn_bin_kernel grid=(256,1,1) block=(1024,1,1) lds=60416
; @launch kernel=mpnn_msg_kernel grid=(256,1,1) block=(768,1,1) lds=132096
.amdgcn_target "amdgcn-amd-amdhsa--gfx950"
.text
.globl mpnn_bin_kernel
.p2align 8
.type mpnn_bin_kernel,@function
mpnn_bin_kernel:
  s_cmp_ge_u32 s2, 256
  s_cbranch_scc1 K1_END
  s_load_dwordx8 s[4:11], s[0:1], 0
  s_load_dwordx4 s[12:15], s[0:1], 32
  s_load_dwordx2 s[16:17], s[0:1], 64
  v_add_u32 v0, 832, v0
  v_and_b32 v0, 1023, v0
  v_lshrrev_b32 v1, 6, v0
  v_lshlrev_b32 v7, 4, v0
  v_readfirstlane_b32 s3, v1
  v_lshlrev_b32 v4, 3, v0
  v_mov_b32 v46, -1
  v_mov_b32 v47, -1
  ds_write_b64 v4, v[46:47] offset:32768
  v_and_b32 v45, 255, v0
  v_lshlrev_b32 v44, 2, v45
  v_lshlrev_b32 v45, 5, v45
  ds_write_b32 v44, v45 offset:40960
  s_and_b32 s40, s2, 7
  s_lshr_b32 s41, s2, 3
  s_mov_b32 s34, 18874368
  s_mov_b32 s35, 0x20000
  s_cmp_ge_u32 s3, 13
  s_cbranch_scc1 K1_P
  s_mul_i32 s18, s2, 3128
  s_sub_u32 s19, 800000, s18
  s_min_u32 s19, s19, 3128
  s_lshl_b32 s36, s18, 2
  s_lshl_b32 s37, s18, 1
  s_mov_b32 s22, 3200000
  s_mov_b32 s23, 0x20000
  s_mov_b32 s26, 3200000
  s_mov_b32 s27, 0x20000
  s_mov_b32 s30, 1600000
  s_mov_b32 s31, 0x20000
  v_lshlrev_b32 v1, 2, v0
  v_cmp_gt_u32 vcc, s19, v1
  s_waitcnt lgkmcnt(0)
  s_mov_b32 s20, s10
  s_mov_b32 s21, s11
  buffer_load_dwordx4 v[8:11], v7, s[20:23], s36 offen
  s_mov_b32 s24, s8
  s_mov_b32 s25, s9
  s_mov_b32 s28, s6
  s_mov_b32 s29, s7
  s_mov_b32 s32, s16
  s_mov_b32 s33, s17
  s_barrier
  buffer_load_dwordx4 v[12:15], v7, s[24:27], s36 offen
  buffer_load_dwordx2 v[16:17], v4, s[28:31], s37 offen
  s_lshl_b32 s42, s40, 5
  s_add_u32 s42, s42, s41
  s_lshl_b32 s43, s42, 5
  s_add_u32 s43, s43, 8388608
  s_lshl_b32 s44, s42, 7
  s_lshl_b32 s42, s42, 6
  s_add_u32 s44, s44, 10485760
  s_add_u32 s42, s42, 4194304
  v_lshrrev_b32 v50, 2, v0
  v_and_b32 v49, 3, v0
  v_lshlrev_b32 v45, 13, v50
  v_lshl_add_u32 v45, v49, 3, v45
  v_lshlrev_b32 v44, 1, v45
  v_lshl_add_u32 v52, v50, 14, v44
  v_lshlrev_b32 v46, 7, v50
  v_lshl_add_u32 v46, v49, 4, v46
  v_and_b32 v47, 64, v0
  v_add_u32 v46, v46, v47
  v_xor_b32 v47, 64, v46
  v_bfe_u32 v48, v0, 4, 2
  v_xor_b32 v49, v49, v48
  v_lshlrev_b32 v50, 5, v50
  v_lshl_add_u32 v49, v49, 2, v50
  v_add_u32 v49, 16, v49
  v_add_u32 v49, 16, v50
  v_add_u32 v50, 32, v50
  v_and_b32 v48, 0x3fc, v0
  v_lshlrev_b32 v51, 3, v0
  v_mov_b32 v6, 1
  s_movk_i32 s38, -98
  s_mov_b32 s39, 0xffff0000
  s_mov_b64 exec, vcc
  s_cbranch_execz K1_B1
  s_waitcnt vmcnt(2)
  v_mul_u32_u24 v20, 21400, v8
  v_lshrrev_b32 v20, 21, v20
  v_lshlrev_b32 v28, 2, v20
  ds_add_rtn_u32 v28, v28, v6 offset:40960
  v_mul_u32_u24 v21, 21400, v9
  v_lshrrev_b32 v21, 21, v21
  v_lshlrev_b32 v29, 2, v21
  ds_add_rtn_u32 v29, v29, v6 offset:40960
  v_mul_u32_u24 v22, 21400, v10
  v_lshrrev_b32 v22, 21, v22
  v_lshlrev_b32 v30, 2, v22
  ds_add_rtn_u32 v30, v30, v6 offset:40960
  v_mul_u32_u24 v23, 21400, v11
  v_lshrrev_b32 v23, 21, v23
  v_lshlrev_b32 v31, 2, v23
  ds_add_rtn_u32 v31, v31, v6 offset:40960
  v_mad_i32_i24 v24, v20, s38, v8
  v_lshl_or_b32 v32, v20, 5, 31
  v_and_b32 v20, 31, v20
  v_mad_i32_i24 v25, v21, s38, v9
  v_lshl_or_b32 v33, v21, 5, 31
  v_and_b32 v21, 31, v21
  v_mad_i32_i24 v26, v22, s38, v10
  v_lshl_or_b32 v34, v22, 5, 31
  v_and_b32 v22, 31, v22
  v_mad_i32_i24 v27, v23, s38, v11
  v_lshl_or_b32 v35, v23, 5, 31
  v_and_b32 v23, 31, v23
  s_waitcnt lgkmcnt(3)
  v_min_u32 v28, v28, v32
  v_xor_b32 v28, v28, v20
  ds_write_b8 v28, v24 offset:32768
  s_waitcnt lgkmcnt(3)
  v_min_u32 v29, v29, v33
  v_xor_b32 v29, v29, v21
  ds_write_b8 v29, v25 offset:32768
  s_waitcnt lgkmcnt(3)
  v_min_u32 v30, v30, v34
  v_xor_b32 v30, v30, v22
  ds_write_b8 v30, v26 offset:32768
  s_waitcnt lgkmcnt(3)
  v_min_u32 v31, v31, v35
  v_xor_b32 v31, v31, v23
  ds_write_b8 v31, v27 offset:32768
  v_lshlrev_b32 v32, 2, v28
  v_lshlrev_b32 v33, 2, v29
  v_lshlrev_b32 v34, 2, v30
  v_lshlrev_b32 v35, 2, v31
  s_waitcnt vmcnt(0)
  v_lshl_or_b32 v36, v16, 16, v12
  ds_write_b32 v32, v36
  v_and_or_b32 v37, v16, s39, v13
  ds_write_b32 v33, v37
  v_lshl_or_b32 v38, v17, 16, v14
  ds_write_b32 v34, v38
  v_and_or_b32 v39, v17, s39, v15
  ds_write_b32 v35, v39
K1_B1:
  s_mov_b64 exec, -1
  s_waitcnt lgkmcnt(0)
  s_barrier
  ds_read_b128 v[8:11], v46
  ds_read_b32 v18, v48 offset:40960
  ds_read_b64 v[16:17], v51 offset:32768
  ds_read_b128 v[12:15], v47
  s_waitcnt lgkmcnt(3)
  buffer_store_dwordx4 v[8:11], v44, s[32:35], s42 offen
  s_waitcnt lgkmcnt(1)
  v_cmp_gt_u32 vcc, v18, v50
  v_cmp_gt_u32 s[46:47], v18, v49
  s_cbranch_vccnz K1_OV
K1_OVR:
  buffer_store_dwordx2 v[16:17], v45, s[32:35], s43 offen
  s_mov_b64 exec, s[46:47]
  s_waitcnt lgkmcnt(0)
  buffer_store_dwordx4 v[12:15], v52, s[32:35], s44 offen
K1_END:
  s_endpgm
K1_OV:
  v_mov_b32 v18, 0xfefefefe
  v_cndmask_b32 v16, v16, v18, vcc
  v_cndmask_b32 v17, v17, v18, vcc
  s_branch K1_OVR
K1_P:
  v_and_b32 v1, 15, v0
  v_bfe_u32 v2, v0, 4, 2
  v_lshlrev_b32 v3, 10, v2
  v_lshl_add_u32 v5, v1, 1, v3
  v_lshl_add_u32 v3, v1, 3, v3
  v_lshlrev_b32 v4, 7, v1
  v_lshl_add_u32 v4, v2, 4, v4
  v_bfe_u32 v6, v0, 1, 2
  v_lshlrev_b32 v3, 10, v2
  v_lshl_add_u32 v3, v6, 5, v3
  v_and_b32 v6, 8, v0
  v_lshl_add_u32 v3, v6, 1, v3
  v_and_b32 v6, 1, v0
  v_lshl_add_u32 v3, v6, 3, v3
  v_lshlrev_b32 v7, 9, v2
  v_lshl_add_u32 v7, v1, 3, v7
  v_and_b32 v55, 63, v0
  v_xor_b32 v55, v55, v2
  v_lshlrev_b32 v55, 4, v55
  v_xor_b32 v56, 64, v55
  s_mul_i32 s52, s3, 6144
  s_add_u32 s52, s52, -37888
  v_lshrrev_b32 v4, 1, v1
  v_xor_b32 v4, v4, v2
  v_lshlrev_b32 v4, 4, v4
  v_lshl_add_u32 v4, v1, 7, v4
  v_add_u32 v4, s52, v4
  s_mul_i32 s18, s41, 3
  s_add_u32 s18, s18, s3
  s_sub_u32 s18, s18, 13
  s_mul_i32 s36, s40, 196
  s_add_u32 s36, s36, s18
  s_lshl_b32 s36, s36, 11
  s_add_u32 s37, s36, 196608
  s_add_u32 s38, s36, 393216
  s_movk_i32 s39, 4096
  s_mov_b32 s22, 16512
  s_mov_b32 s23, 0x20000
  s_mov_b32 s26, 3200000
  s_mov_b32 s27, 0x20000
  s_mov_b32 s30, 3200000
  s_mov_b32 s31, 0x20000
  s_mov_b32 s50, 16384
  s_mov_b32 s51, 0x20000
  s_sub_u32 s19, s2, 16
  s_cmp_eq_u32 s3, 15
  s_cselect_b32 s19, s19, 100
  s_waitcnt lgkmcnt(0)
  s_mov_b32 s24, s4
  s_mov_b32 s25, s5
  s_mov_b32 s20, s12
  s_mov_b32 s21, s13
  s_cmp_le_u32 s19, 24
  s_cbranch_scc1 K1_FL
K1_FLR:
  s_add_u32 m0, s52, 0
  s_nop 0
  buffer_load_dwordx4 v55, s[24:27], s36 offen lds
  buffer_load_dwordx4 v56, s[24:27], s36 offen offset:1024 lds
  s_add_u32 m0, s52, 2048
  s_nop 0
  buffer_load_dwordx4 v55, s[24:27], s37 offen lds
  buffer_load_dwordx4 v56, s[24:27], s37 offen offset:1024 lds
  buffer_load_dwordx2 v[8:9], v3, s[20:23], 0 offen offset:0
  buffer_load_dwordx2 v[10:11], v3, s[20:23], 0 offen offset:128
  buffer_load_dwordx2 v[12:13], v3, s[20:23], 0 offen offset:256
  buffer_load_dwordx2 v[14:15], v3, s[20:23], 0 offen offset:384
  buffer_load_dwordx2 v[16:17], v3, s[20:23], 0 offen offset:512
  buffer_load_dwordx2 v[18:19], v3, s[20:23], 0 offen offset:640
  buffer_load_dwordx2 v[20:21], v3, s[20:23], 0 offen offset:768
  buffer_load_dwordx2 v[22:23], v3, s[20:23], 0 offen offset:896
  buffer_load_dwordx2 v[24:25], v3, s[20:23], s39 offen offset:0
  buffer_load_dwordx2 v[26:27], v3, s[20:23], s39 offen offset:128
  buffer_load_dwordx2 v[28:29], v3, s[20:23], s39 offen offset:256
  buffer_load_dwordx2 v[30:31], v3, s[20:23], s39 offen offset:384
  buffer_load_dwordx2 v[32:33], v3, s[20:23], s39 offen offset:512
  buffer_load_dwordx2 v[34:35], v3, s[20:23], s39 offen offset:640
  buffer_load_dwordx2 v[36:37], v3, s[20:23], s39 offen offset:768
  buffer_load_dwordx2 v[38:39], v3, s[20:23], s39 offen offset:896
  s_cmp_lt_u32 s18, 4
  s_cselect_b64 exec, -1, 0
  s_add_u32 m0, s52, 4096
  s_nop 0
  buffer_load_dwordx4 v55, s[24:27], s38 offen lds
  buffer_load_dwordx4 v56, s[24:27], s38 offen offset:1024 lds
  s_mov_b64 exec, -1
  v_xor_b32 v3, 64, v4
  s_barrier
  s_mov_b32 s28, s16
  s_mov_b32 s29, s17
  s_mov_b32 s32, s16
  s_mov_b32 s33, s17
  s_mov_b32 s44, 0x05040100
  s_mov_b32 s45, 0x07060302
  s_mov_b32 s46, 0xbfb8aa3b
  s_mov_b32 s47, 0xbfb8aa3b
  s_waitcnt vmcnt(2)
  ds_read_b128 v[72:75], v4 offset:0
  ds_read_b128 v[76:79], v3 offset:0
  ds_read_b128 v[80:83], v4 offset:2048
  ds_read_b128 v[84:87], v3 offset:2048
  v_perm_b32 v40, v10, v8, s44
  v_perm_b32 v41, v14, v12, s44
  v_perm_b32 v42, v18, v16, s44
  v_perm_b32 v43, v22, v20, s44
  v_perm_b32 v44, v26, v24, s44
  v_perm_b32 v45, v30, v28, s44
  v_perm_b32 v46, v34, v32, s44
  v_perm_b32 v47, v38, v36, s44
  v_perm_b32 v48, v10, v8, s45
  v_perm_b32 v49, v14, v12, s45
  v_perm_b32 v50, v18, v16, s45
  v_perm_b32 v51, v22, v20, s45
  v_perm_b32 v52, v26, v24, s45
  v_perm_b32 v53, v30, v28, s45
  v_perm_b32 v54, v34, v32, s45
  v_perm_b32 v55, v38, v36, s45
  v_perm_b32 v56, v11, v9, s44
  v_perm_b32 v57, v15, v13, s44
  v_perm_b32 v58, v19, v17, s44
  v_perm_b32 v59, v23, v21, s44
  v_perm_b32 v60, v27, v25, s44
  v_perm_b32 v61, v31, v29, s44
  v_perm_b32 v62, v35, v33, s44
  v_perm_b32 v63, v39, v37, s44
  v_perm_b32 v64, v11, v9, s45
  v_perm_b32 v65, v15, v13, s45
  v_perm_b32 v66, v19, v17, s45
  v_perm_b32 v67, v23, v21, s45
  v_perm_b32 v68, v27, v25, s45
  v_perm_b32 v69, v31, v29, s45
  v_perm_b32 v70, v35, v33, s45
  v_perm_b32 v71, v39, v37, s45
  s_waitcnt lgkmcnt(0)
  v_mfma_f32_16x16x32_bf16 v[96:99], v[72:75], v[40:43], 0
  v_mfma_f32_16x16x32_bf16 v[100:103], v[72:75], v[48:51], 0
  v_mfma_f32_16x16x32_bf16 v[104:107], v[72:75], v[56:59], 0
  v_mfma_f32_16x16x32_bf16 v[108:111], v[72:75], v[64:67], 0
  v_mfma_f32_16x16x32_bf16 v[96:99], v[76:79], v[44:47], v[96:99]
  v_mfma_f32_16x16x32_bf16 v[100:103], v[76:79], v[52:55], v[100:103]
  v_mfma_f32_16x16x32_bf16 v[104:107], v[76:79], v[60:63], v[104:107]
  v_mfma_f32_16x16x32_bf16 v[108:111], v[76:79], v[68:71], v[108:111]
  s_nop 4
  v_pk_mul_f32 v[96:97], v[96:97], s[46:47]
  v_pk_mul_f32 v[98:99], v[98:99], s[46:47]
  v_pk_mul_f32 v[100:101], v[100:101], s[46:47]
  v_pk_mul_f32 v[102:103], v[102:103], s[46:47]
  v_pk_mul_f32 v[104:105], v[104:105], s[46:47]
  v_pk_mul_f32 v[106:107], v[106:107], s[46:47]
  v_pk_mul_f32 v[108:109], v[108:109], s[46:47]
  v_pk_mul_f32 v[110:111], v[110:111], s[46:47]
  v_cvt_pk_bf16_f32 v112, v96, v100
  v_cvt_pk_bf16_f32 v113, v104, v108
  v_cvt_pk_bf16_f32 v114, v97, v101
  v_cvt_pk_bf16_f32 v115, v105, v109
  v_cvt_pk_bf16_f32 v116, v98, v102
  v_cvt_pk_bf16_f32 v117, v106, v110
  v_cvt_pk_bf16_f32 v118, v99, v103
  v_cvt_pk_bf16_f32 v119, v107, v111
  buffer_store_dwordx2 v[112:113], v7, s[28:31], s36 offen offset:0 nt
  buffer_store_dwordx2 v[114:115], v7, s[28:31], s36 offen offset:128 nt
  buffer_store_dwordx2 v[116:117], v7, s[28:31], s36 offen offset:256 nt
  buffer_store_dwordx2 v[118:119], v7, s[28:31], s36 offen offset:384 nt
  v_mfma_f32_16x16x32_bf16 v[96:99], v[80:83], v[40:43], 0
  v_mfma_f32_16x16x32_bf16 v[100:103], v[80:83], v[48:51], 0
  v_mfma_f32_16x16x32_bf16 v[104:107], v[80:83], v[56:59], 0
  v_mfma_f32_16x16x32_bf16 v[108:111], v[80:83], v[64:67], 0
  v_mfma_f32_16x16x32_bf16 v[96:99], v[84:87], v[44:47], v[96:99]
  v_mfma_f32_16x16x32_bf16 v[100:103], v[84:87], v[52:55], v[100:103]
  v_mfma_f32_16x16x32_bf16 v[104:107], v[84:87], v[60:63], v[104:107]
  v_mfma_f32_16x16x32_bf16 v[108:111], v[84:87], v[68:71], v[108:111]
  s_nop 4
  v_pk_mul_f32 v[96:97], v[96:97], s[46:47]
  v_pk_mul_f32 v[98:99], v[98:99], s[46:47]
  v_pk_mul_f32 v[100:101], v[100:101], s[46:47]
  v_pk_mul_f32 v[102:103], v[102:103], s[46:47]
  v_pk_mul_f32 v[104:105], v[104:105], s[46:47]
  v_pk_mul_f32 v[106:107], v[106:107], s[46:47]
  v_pk_mul_f32 v[108:109], v[108:109], s[46:47]
  v_pk_mul_f32 v[110:111], v[110:111], s[46:47]
  v_cvt_pk_bf16_f32 v112, v96, v100
  v_cvt_pk_bf16_f32 v113, v104, v108
  v_cvt_pk_bf16_f32 v114, v97, v101
  v_cvt_pk_bf16_f32 v115, v105, v109
  v_cvt_pk_bf16_f32 v116, v98, v102
  v_cvt_pk_bf16_f32 v117, v106, v110
  v_cvt_pk_bf16_f32 v118, v99, v103
  v_cvt_pk_bf16_f32 v119, v107, v111
  buffer_store_dwordx2 v[112:113], v7, s[28:31], s37 offen offset:0 nt
  buffer_store_dwordx2 v[114:115], v7, s[28:31], s37 offen offset:128 nt
  buffer_store_dwordx2 v[116:117], v7, s[28:31], s37 offen offset:256 nt
  buffer_store_dwordx2 v[118:119], v7, s[28:31], s37 offen offset:384 nt
  s_cmp_ge_u32 s18, 4
  s_cbranch_scc1 K1_PD
  s_waitcnt vmcnt(8)
  ds_read_b128 v[88:91], v4 offset:4096
  ds_read_b128 v[92:95], v3 offset:4096
  s_waitcnt lgkmcnt(0)
  v_mfma_f32_16x16x32_bf16 v[96:99], v[88:91], v[40:43], 0
  v_mfma_f32_16x16x32_bf16 v[100:103], v[88:91], v[48:51], 0
  v_mfma_f32_16x16x32_bf16 v[104:107], v[88:91], v[56:59], 0
  v_mfma_f32_16x16x32_bf16 v[108:111], v[88:91], v[64:67], 0
  v_mfma_f32_16x16x32_bf16 v[96:99], v[92:95], v[44:47], v[96:99]
  v_mfma_f32_16x16x32_bf16 v[100:103], v[92:95], v[52:55], v[100:103]
  v_mfma_f32_16x16x32_bf16 v[104:107], v[92:95], v[60:63], v[104:107]
  v_mfma_f32_16x16x32_bf16 v[108:111], v[92:95], v[68:71], v[108:111]
  s_nop 4
  v_pk_mul_f32 v[96:97], v[96:97], s[46:47]
  v_pk_mul_f32 v[98:99], v[98:99], s[46:47]
  v_pk_mul_f32 v[100:101], v[100:101], s[46:47]
  v_pk_mul_f32 v[102:103], v[102:103], s[46:47]
  v_pk_mul_f32 v[104:105], v[104:105], s[46:47]
  v_pk_mul_f32 v[106:107], v[106:107], s[46:47]
  v_pk_mul_f32 v[108:109], v[108:109], s[46:47]
  v_pk_mul_f32 v[110:111], v[110:111], s[46:47]
  v_cvt_pk_bf16_f32 v112, v96, v100
  v_cvt_pk_bf16_f32 v113, v104, v108
  v_cvt_pk_bf16_f32 v114, v97, v101
  v_cvt_pk_bf16_f32 v115, v105, v109
  v_cvt_pk_bf16_f32 v116, v98, v102
  v_cvt_pk_bf16_f32 v117, v106, v110
  v_cvt_pk_bf16_f32 v118, v99, v103
  v_cvt_pk_bf16_f32 v119, v107, v111
  buffer_store_dwordx2 v[112:113], v7, s[28:31], s38 offen offset:0 nt
  buffer_store_dwordx2 v[114:115], v7, s[28:31], s38 offen offset:128 nt
  buffer_store_dwordx2 v[116:117], v7, s[28:31], s38 offen offset:256 nt
  buffer_store_dwordx2 v[118:119], v7, s[28:31], s38 offen offset:384 nt
K1_PD:
  s_cmp_le_u32 s19, 24
  s_cbranch_scc1 K1_FS
K1_PE:
  s_lshr_b32 s19, s2, 5
  s_add_u32 s19, s19, s3
  s_cmp_lg_u32 s19, 18
  s_cbranch_scc1 K1_NPF
  s_getpc_b64 s[48:49]
K1_PC:
  s_add_u32 s48, s48, mpnn_msg_kernel-K1_PC
  s_addc_u32 s49, s49, 0
  v_and_b32 v54, 63, v0
  v_lshlrev_b32 v54, 7, v54
  v_add_u32 v56, 8192, v54
  v_min_u32 v56, K2_MARK-mpnn_msg_kernel, v56
  global_load_dword v57, v56, s[48:49]
  v_min_u32 v54, K2_END-mpnn_msg_kernel, v54
  global_load_dword v55, v54, s[48:49]
K1_NPF:
  s_lshl_b32 s42, s40, 5
  s_add_u32 s42, s42, s41
  s_lshl_b32 s43, s42, 5
  s_add_u32 s43, s43, 8388608
  s_lshl_b32 s44, s42, 7
  s_lshl_b32 s42, s42, 6
  s_add_u32 s44, s44, 10485760
  s_add_u32 s42, s42, 4194304
  v_lshrrev_b32 v50, 2, v0
  v_and_b32 v49, 3, v0
  v_lshlrev_b32 v45, 13, v50
  v_lshl_add_u32 v45, v49, 3, v45
  v_lshlrev_b32 v44, 1, v45
  v_lshl_add_u32 v52, v50, 14, v44
  v_lshlrev_b32 v46, 7, v50
  v_lshl_add_u32 v46, v49, 4, v46
  v_and_b32 v47, 64, v0
  v_add_u32 v46, v46, v47
  v_xor_b32 v47, 64, v46
  v_bfe_u32 v48, v0, 4, 2
  v_xor_b32 v49, v49, v48
  v_lshlrev_b32 v50, 5, v50
  v_lshl_add_u32 v49, v49, 2, v50
  v_add_u32 v49, 16, v49
  v_add_u32 v49, 16, v50
  v_add_u32 v50, 32, v50
  v_and_b32 v48, 0x3fc, v0
  v_lshlrev_b32 v51, 3, v0
  s_branch K1_B1
K1_FL:
  s_cmp_eq_u32 s19, 8
  s_cbranch_scc1 K1_FA
  s_cmp_gt_u32 s19, 8
  s_cbranch_scc1 K1_FU
  s_lshr_b32 s42, s19, 1
  s_and_b32 s43, s19, 1
  s_lshl_b32 s42, s42, 5
  s_lshl_b32 s43, s43, 12
  s_add_u32 s43, s43, s42
  s_add_u32 s43, s43, 8192
  buffer_load_ushort v120, v5, s[20:23], s43 offen offset:0
  buffer_load_ushort v121, v5, s[20:23], s43 offen offset:128
  buffer_load_ushort v122, v5, s[20:23], s43 offen offset:256
  buffer_load_ushort v123, v5, s[20:23], s43 offen offset:384
  buffer_load_ushort v124, v5, s[20:23], s43 offen offset:512
  buffer_load_ushort v125, v5, s[20:23], s43 offen offset:640
  buffer_load_ushort v126, v5, s[20:23], s43 offen offset:768
  buffer_load_ushort v127, v5, s[20:23], s43 offen offset:896
  s_branch K1_FLR
K1_FU:
  s_mov_b32 s48, s14
  s_mov_b32 s49, s15
  s_sub_u32 s43, s19, 9
  s_lshr_b32 s42, s43, 3
  s_lshl_b32 s42, s42, 6
  s_bfe_u32 s44, s43, 0x10002
  s_lshl_b32 s44, s44, 1
  s_add_u32 s42, s42, s44
  s_and_b32 s43, s43, 3
  s_lshl_b32 s43, s43, 12
  s_add_u32 s43, s43, s42
  v_lshl_add_u32 v5, v1, 1, v5
  buffer_load_ushort v120, v5, s[48:51], s43 offen offset:0
  buffer_load_ushort v121, v5, s[48:51], s43 offen offset:128
  buffer_load_ushort v122, v5, s[48:51], s43 offen offset:256
  buffer_load_ushort v123, v5, s[48:51], s43 offen offset:384
  buffer_load_ushort v124, v5, s[48:51], s43 offen offset:512
  buffer_load_ushort v125, v5, s[48:51], s43 offen offset:640
  buffer_load_ushort v126, v5, s[48:51], s43 offen offset:768
  buffer_load_ushort v127, v5, s[48:51], s43 offen offset:896
  s_branch K1_FLR
K1_FA:
  v_bfe_u32 v5, v0, 3, 2
  v_and_b32 v6, 3, v0
  v_lshl_add_u32 v5, v5, 2, v6
  v_lshlrev_b32 v5, 1, v5
  s_movk_i32 s43, 16384
  buffer_load_ushort v120, v5, s[20:23], s43 offen offset:0
  buffer_load_ushort v121, v5, s[20:23], s43 offen offset:32
  buffer_load_ushort v122, v5, s[20:23], s43 offen offset:64
  buffer_load_ushort v123, v5, s[20:23], s43 offen offset:96
  s_branch K1_FLR
K1_FS:
  v_and_b32 v5, 63, v0
  v_lshlrev_b32 v5, 4, v5
  s_lshl_b32 s36, s19, 10
  s_add_u32 s36, s36, 3670016
  s_cmp_eq_u32 s19, 8
  s_cbranch_scc1 K1_AE
  s_mov_b32 s37, 0x666600
  s_bitcmp0_b32 s37, s19
  s_cbranch_scc1 K1_FR
  v_lshlrev_b32 v120, 16, v120
  v_mul_f32 v120, s46, v120
  v_lshlrev_b32 v121, 16, v121
  v_mul_f32 v121, s46, v121
  v_lshlrev_b32 v122, 16, v122
  v_mul_f32 v122, s46, v122
  v_lshlrev_b32 v123, 16, v123
  v_mul_f32 v123, s46, v123
  v_lshlrev_b32 v124, 16, v124
  v_mul_f32 v124, s46, v124
  v_lshlrev_b32 v125, 16, v125
  v_mul_f32 v125, s46, v125
  v_lshlrev_b32 v126, 16, v126
  v_mul_f32 v126, s46, v126
  v_lshlrev_b32 v127, 16, v127
  v_mul_f32 v127, s46, v127
  v_cvt_pk_bf16_f32 v8, v120, v121
  v_cvt_pk_bf16_f32 v9, v122, v123
  v_cvt_pk_bf16_f32 v10, v124, v125
  v_cvt_pk_bf16_f32 v11, v126, v127
  buffer_store_dwordx4 v[8:11], v5, s[32:35], s36 offen
  s_branch K1_PE
K1_FR:
  v_lshl_or_b32 v8, v121, 16, v120
  v_lshl_or_b32 v9, v123, 16, v122
  v_lshl_or_b32 v10, v125, 16, v124
  v_lshl_or_b32 v11, v127, 16, v126
  buffer_store_dwordx4 v[8:11], v5, s[32:35], s36 offen
  s_branch K1_PE
K1_AE:
  v_bfe_u32 v2, v0, 2, 1
  v_bfe_u32 v3, v0, 5, 1
  v_cmp_eq_u32 vcc, v2, v3
  v_lshlrev_b32 v120, 16, v120
  v_mul_f32 v120, s46, v120
  v_cvt_pk_bf16_f32 v120, 0, v120
  v_cndmask_b32 v8, 0, v120, vcc
  v_lshlrev_b32 v121, 16, v121
  v_mul_f32 v121, s46, v121
  v_cvt_pk_bf16_f32 v121, 0, v121
  v_cndmask_b32 v9, 0, v121, vcc
  v_lshlrev_b32 v122, 16, v122
  v_mul_f32 v122, s46, v122
  v_cvt_pk_bf16_f32 v122, 0, v122
  v_cndmask_b32 v10, 0, v122, vcc
  v_lshlrev_b32 v123, 16, v123
  v_mul_f32 v123, s46, v123
  v_cvt_pk_bf16_f32 v123, 0, v123
  v_cndmask_b32 v11, 0, v123, vcc
  buffer_store_dwordx4 v[8:11], v5, s[32:35], s36 offen
  s_branch K1_PE
.globl mpnn_msg_kernel
.p2align 8
.type mpnn_msg_kernel,@function
mpnn_msg_kernel:
  s_cmp_ge_u32 s2, 256
  s_cbranch_scc1 K2_END
  s_load_dwordx2 s[20:21], s[0:1], 64
  s_load_dwordx16 s[4:19], s[0:1], 0
  v_lshrrev_b32 v1, 6, v0
  v_lshlrev_b32 v2, 4, v0
  v_readfirstlane_b32 s3, v1
  v_mov_b32 v8, 0
  v_mov_b32 v9, 0
  v_mov_b32 v10, 0
  v_mov_b32 v11, 0
  v_add_u32 v4, 89088, v2
  v_and_b32 v5, 255, v0
  v_lshlrev_b32 v5, 2, v5
  v_add_u32 v6, 89088, v5
  v_cmp_gt_u32 vcc, 392, v5
  s_and_b32 s76, s2, 7
  s_lshl_b32 s76, s76, 5
  s_lshr_b32 s64, s2, 3
  s_add_u32 s76, s76, s64
  v_cndmask_b32 v6, 0, v6, vcc
  ds_write_b32 v5, v6 offset:46592
  ds_write_b128 v4, v[8:11] offset:0
  ds_write_b128 v4, v[8:11] offset:12288
  ds_write_b128 v4, v[8:11] offset:24576
  v_lshlrev_b32 v5, 3, v0
  v_add_u32 v5, 125952, v5
  ds_write_b64 v5, v[8:9]
  s_lshl_b32 s64, s76, 14
  s_lshl_b32 s62, s76, 15
  s_add_u32 s62, s62, 10485760
  s_add_u32 s64, s64, 4190208
  s_add_u32 s65, s64, 8192
  s_lshl_b32 s66, s76, 13
  s_and_b32 s67, s76, 16
  s_add_u32 s66, s66, s67
  s_add_u32 s66, s66, 8388608
  s_xor_b32 s60, s66, 16
  s_sub_u32 s66, s66, 2048
  s_add_u32 s67, s66, 4096
  s_mul_i32 s69, s76, 98
  s_sub_u32 s70, 25000, s69
  s_min_u32 s70, s70, 98
  s_lshl_b32 s70, s70, 7
  s_lshl_b32 s71, s69, 7
  s_and_b32 s72, s3, 3
  s_lshr_b32 s73, s3, 2
  s_mov_b32 s26, 18874368
  s_mov_b32 s27, 0x20000
  s_mov_b32 s34, s70
  s_mov_b32 s35, 0x20000
  v_and_b32 v4, 3, v0
  v_and_b32 v6, 63, v0
  v_lshlrev_b32 v6, 4, v6
  v_lshlrev_b32 v3, 5, v0
  v_lshrrev_b32 v5, 2, v0
  v_lshlrev_b32 v5, 5, v5
  v_lshl_add_u32 v158, v4, 2, v5
  v_lshlrev_b32 v166, 3, v6
  s_andn2_b32 s77, s2, 7
  s_add_u32 s77, s77, s3
  s_sub_u32 s77, s77, 4
  s_mul_i32 s77, s77, 1536
  s_and_b32 s61, s2, 7
  s_mul_i32 s61, s61, 400896
  s_add_u32 s77, s77, s61
  s_cmp_eq_u32 s73, 0
  s_cbranch_scc0 K2_KW
  v_mov_b32 v76, 0xfefefefe
  v_lshlrev_b32 v16, 2, v0
  v_add_u32 v17, 89088, v16
  v_add_u32 v18, 89344, v16
  v_mov_b32 v19, 4644
  v_mov_b32 v20, 37152
  v_mul_u32_u24 v21, 516, v0
  v_sub_u32 v21, 126704, v21
  v_mov_b32 v22, 4
K2_KW:
  s_waitcnt lgkmcnt(0)
  s_mov_b32 s24, s20
  s_mov_b32 s25, s21
  s_cbranch_scc0 K2_A1
  buffer_load_dwordx4 v[104:107], v3, s[24:27], s60 offen
  s_add_u32 s32, s4, s71
  s_addc_u32 s33, s5, 0
  v_bfe_u32 v7, v0, 4, 2
  v_lshlrev_b32 v7, 4, v7
  v_xor_b32 v7, v7, v6
  v_xor_b32 v158, 64, v7
  s_lshl_b32 s60, s3, 11
  s_add_u32 s61, s60, 49152
  s_add_u32 m0, s60, 63488
  s_add_u32 s63, s60, 3670016
  s_barrier
  buffer_load_dwordx4 v6, s[24:27], s63 offen lds
  buffer_load_dwordx4 v6, s[24:27], s63 offen offset:1024 lds
  s_mov_b32 m0, s61
  v_lshlrev_b32 v3, 7, v0
  buffer_load_dwordx4 v7, s[32:35], s60 offen lds
  buffer_load_dwordx4 v158, s[32:35], s60 offen offset:1024 lds
  s_add_u32 m0, s61, 8192
  s_add_u32 s60, s60, 8192
  s_cmp_eq_u32 s3, 3
  s_cbranch_scc1 K2_A3
  buffer_load_dwordx4 v7, s[32:35], s60 offen lds
  buffer_load_dwordx4 v158, s[32:35], s60 offen offset:1024 lds
  s_branch K2_A2
K2_A3:
  s_mov_b32 m0, 71680
  s_mov_b32 s60, 3678208
  buffer_load_dwordx4 v6, s[24:27], s60 offen lds
  s_mov_b64 exec, 0
  buffer_load_dwordx4 v6, s[24:27], s60 offen lds
  s_mov_b64 exec, -1
  s_branch K2_A2
K2_A1:
  buffer_load_dword v104, v158, s[24:27], s66 offen
  buffer_load_dword v105, v158, s[24:27], s67 offen
  s_barrier
  buffer_load_dwordx4 v[56:59], v2, s[24:27], s64 offen
  buffer_load_dwordx4 v[60:63], v2, s[24:27], s65 offen
K2_A2:
  v_mov_b32 v5, 516
  s_mov_b32 s54, 0x456a3210
  v_lshlrev_b32 v153, 4, v4
  s_mov_b32 s55, 0x789b
  v_and_b32 v72, 15, v0
  s_lshl_b32 s23, s3, 2
  v_bfe_u32 v73, v0, 4, 2
  s_lshr_b64 s[54:55], s[54:55], s23
  v_bfe_u32 v74, v0, 1, 3
  s_and_b32 s23, s54, 15
  v_xor_b32 v74, v74, v73
  s_lshl_b32 s23, s23, 5
  s_sub_u32 s23, s23, 8
  v_bfe_u32 v137, v0, 3, 3
  s_mov_b64 s[54:55], 0x3f80
  v_lshl_add_u32 v137, v137, 2, s23
  s_lshr_b32 s22, s3, 1
  v_lshlrev_b64 v[140:141], v153, s[54:55]
  s_lshl_b32 s74, s22, 11
  s_add_u32 s23, s74, 49152
  v_lshl_add_u32 v164, v74, 4, s23
  s_lshl_b32 s75, s22, 7
  v_lshl_add_u32 v164, v72, 7, v164
  s_add_u32 s75, s75, 12288
  v_lshlrev_b32 v162, 9, v73
  s_mul_i32 s23, s22, 2304
  v_lshl_add_u32 v162, v72, 2, v162
  s_movk_i32 s54, 144
  v_and_or_b32 v163, v0, 48, s23
  s_cmp_eq_u32 s3, 0
  v_mad_u32_u24 v163, v72, s54, v163
  s_cselect_b32 s56, 0xffff, 0
  s_mov_b32 s57, 0
  s_mov_b32 s59, 0x0f0f0f0f
  s_or_b32 s58, s59, s56
  s_andn2_b32 s54, s59, s56
  s_mov_b32 s55, s59
  v_cndmask_b32 v112, 1, 0, s[56:57]
  s_mov_b32 s23, 0xffa3cf00
  v_cndmask_b32 v113, v5, 0, s[58:59]
  v_cndmask_b32 v114, 0, 1, s[54:55]
  v_cndmask_b32 v161, 0, 1.0, s[54:55]
  v_lshl_add_u32 v115, v4, 6, s23
  s_mov_b32 s23, 0xffcf1000
  v_and_or_b32 v162, v0, 64, v162
  v_lshl_add_u32 v116, v4, 5, s23
  v_mov_b32 v125, v153
  v_mov_b32 v127, v153
  v_mov_b32 v129, v153
  v_mov_b32 v131, v153
  s_cmp_lg_u32 s73, 1
  s_cbranch_scc1 K2_K1
  s_lshr_b32 s23, s72, 1
  s_mul_i32 s54, s23, 17408
  s_and_b32 s55, s72, 1
  s_lshl_b32 s56, s55, 7
  s_add_u32 s54, s54, s56
  s_add_u32 s54, s54, 16128
  v_and_or_b32 v1, v0, 48, s54
  s_movk_i32 s54, 272
  s_lshl_b32 s23, s23, 13
  v_mad_u32_u24 v1, v72, s54, v1
  s_sub_u32 s23, s23, s74
  v_add_u32 v155, s23, v164
  s_lshl_b32 s55, s55, 12
  s_add_u32 s55, s55, 63488
  v_xor_b32 v156, 64, v155
  v_add_u32 v157, s55, v6
K2_K1:
  s_cmp_lg_u32 s3, 0
  s_cbranch_scc1 K2_K2
  s_mov_b64 exec, 0xffff
  v_and_b32 v137, 12, v0
  v_add_u32 v137, 376, v137
  s_mov_b64 exec, -1
K2_K2:
  s_movk_i32 s64, 392
  s_mov_b32 s28, s20
  s_or_b32 s29, s21, 0x800000
  s_mov_b32 s30, 25000
  s_mov_b32 s31, 0x20000
  s_add_u32 s36, s16, s71
  s_addc_u32 s37, s17, 0
  s_mov_b32 s38, s70
  s_mov_b32 s39, 0x20000
  s_mov_b32 s65, 126640
  s_mov_b32 s68, 0
  s_mov_b32 s71, 0
  s_mov_b32 s70, 0
  s_mov_b32 s66, 0xbfb8aa3b
  s_mov_b32 s67, 0xbfb8aa3b
  s_cmp_eq_u32 s73, 0
  s_cbranch_scc1 K2_CT
  s_waitcnt vmcnt(2)
  v_lshlrev_b32_sdwa v88, 2, v104 dst_sel:DWORD dst_unused:UNUSED_PAD src0_sel:DWORD src1_sel:BYTE_0
  v_lshlrev_b32_sdwa v89, 2, v104 dst_sel:DWORD dst_unused:UNUSED_PAD src0_sel:DWORD src1_sel:BYTE_1
  v_lshlrev_b32_sdwa v90, 2, v104 dst_sel:DWORD dst_unused:UNUSED_PAD src0_sel:DWORD src1_sel:BYTE_2
  v_lshlrev_b32_sdwa v91, 2, v104 dst_sel:DWORD dst_unused:UNUSED_PAD src0_sel:DWORD src1_sel:BYTE_3
  v_cmp_gt_u32 s[40:41], s64, v88
  v_cmp_gt_u32 s[42:43], s64, v89
  v_cmp_gt_u32 s[44:45], s64, v90
  v_cmp_gt_u32 s[46:47], s64, v91
  s_mov_b64 exec, s[40:41]
  ds_add_rtn_u32 v88, v88, v5 offset:46592
  s_mov_b64 exec, s[42:43]
  ds_add_rtn_u32 v89, v89, v5 offset:46592
  s_mov_b64 exec, s[44:45]
  ds_add_rtn_u32 v90, v90, v5 offset:46592
  s_mov_b64 exec, s[46:47]
  ds_add_rtn_u32 v91, v91, v5 offset:46592
  s_mov_b64 exec, -1
  v_lshlrev_b32_sdwa v92, 2, v105 dst_sel:DWORD dst_unused:UNUSED_PAD src0_sel:DWORD src1_sel:BYTE_0
  v_lshlrev_b32_sdwa v93, 2, v105 dst_sel:DWORD dst_unused:UNUSED_PAD src0_sel:DWORD src1_sel:BYTE_1
  v_lshlrev_b32_sdwa v94, 2, v105 dst_sel:DWORD dst_unused:UNUSED_PAD src0_sel:DWORD src1_sel:BYTE_2
  v_lshlrev_b32_sdwa v95, 2, v105 dst_sel:DWORD dst_unused:UNUSED_PAD src0_sel:DWORD src1_sel:BYTE_3
  v_cmp_gt_u32 s[48:49], s64, v92
  v_cmp_gt_u32 s[50:51], s64, v93
  v_cmp_gt_u32 s[52:53], s64, v94
  v_cmp_gt_u32 s[54:55], s64, v95
  s_mov_b64 exec, s[48:49]
  ds_add_rtn_u32 v92, v92, v5 offset:46592
  s_mov_b64 exec, s[50:51]
  ds_add_rtn_u32 v93, v93, v5 offset:46592
  s_mov_b64 exec, s[52:53]
  ds_add_rtn_u32 v94, v94, v5 offset:46592
  s_mov_b64 exec, s[54:55]
  ds_add_rtn_u32 v95, v95, v5 offset:46592
  s_mov_b64 exec, -1
  s_mov_b64 exec, 0xfff
  buffer_load_dword v167, v166, s[24:27], s77 offen
  s_mov_b64 exec, -1
  v_mov_b32 v76, 0
  s_waitcnt lgkmcnt(0)
  s_barrier
K2_AB1:
  ds_read_b32 v77, v76 offset:47040
  s_cmp_eq_u32 s73, 2
  s_cbranch_scc1 K2_AB2
  s_cmp_gt_u32 s72, 1
  s_cselect_b64 s[52:53], 1, -1
  ds_read_b128 v[8:11], v157 offset:0
  ds_read_b128 v[12:15], v157 offset:1024
  ds_read_b128 v[16:19], v157 offset:2048
  ds_read_b128 v[20:23], v157 offset:3072
  ds_read_b128 v[32:35], v155 offset:0
  ds_read_b128 v[36:39], v156 offset:0
  ds_read_b128 v[40:43], v155 offset:2048
  ds_read_b128 v[44:47], v156 offset:2048
  ds_read_b128 v[48:51], v155 offset:4096
  ds_read_b128 v[52:55], v156 offset:4096
  s_mov_b64 exec, s[52:53]
  ds_read_b128 v[96:99], v155 offset:6144
  ds_read_b128 v[100:103], v156 offset:6144
  s_mov_b64 exec, -1
K2_AB2:
  s_waitcnt vmcnt(2) lgkmcnt(11)
  v_min_u32 v88, s65, v88
  ds_write_b32 v88, v56
  v_min_u32 v89, s65, v89
  ds_write_b32 v89, v57
  v_min_u32 v90, s65, v90
  ds_write_b32 v90, v58
  v_min_u32 v91, s65, v91
  ds_write_b32 v91, v59
  s_waitcnt vmcnt(1) lgkmcnt(11)
  v_min_u32 v92, s65, v92
  ds_write_b32 v92, v60
  v_min_u32 v93, s65, v93
  ds_write_b32 v93, v61
  v_min_u32 v94, s65, v94
  ds_write_b32 v94, v62
  v_min_u32 v95, s65, v95
  ds_write_b32 v95, v63
  s_waitcnt lgkmcnt(8)
  v_readfirstlane_b32 s23, v77
  v_cmp_eq_u32 s[44:45], 0, v4
  v_cmp_eq_u32 s[46:47], 1, v4
  v_cmp_eq_u32 s[48:49], 2, v4
  v_cmp_eq_u32 s[50:51], 3, v4
  s_andn2_b32 s23, s23, s68
  s_cbranch_scc1 K2_RESCAN
  v_add_u32 v7, 71680, v6
  s_cmp_eq_u32 s73, 2
  s_cbranch_scc1 K2_G2
  v_mfma_f32_16x16x32_bf16 v[72:75], v[8:11], v[32:35], 0
  v_mfma_f32_16x16x32_bf16 v[76:79], v[16:19], v[32:35], 0
  v_mfma_f32_16x16x32_bf16 v[72:75], v[12:15], v[36:39], v[72:75]
  v_mfma_f32_16x16x32_bf16 v[76:79], v[20:23], v[36:39], v[76:79]
  v_mfma_f32_16x16x32_bf16 v[80:83], v[8:11], v[40:43], 0
  v_mfma_f32_16x16x32_bf16 v[84:87], v[16:19], v[40:43], 0
  v_mfma_f32_16x16x32_bf16 v[80:83], v[12:15], v[44:47], v[80:83]
  v_mfma_f32_16x16x32_bf16 v[84:87], v[20:23], v[44:47], v[84:87]
  v_mfma_f32_16x16x32_bf16 v[64:67], v[8:11], v[48:51], 0
  v_mfma_f32_16x16x32_bf16 v[68:71], v[16:19], v[48:51], 0
  v_mfma_f32_16x16x32_bf16 v[64:67], v[12:15], v[52:55], v[64:67]
  v_mfma_f32_16x16x32_bf16 v[68:71], v[20:23], v[52:55], v[68:71]
  s_waitcnt lgkmcnt(0)
  v_mfma_f32_16x16x32_bf16 v[56:59], v[8:11], v[96:99], 0
  v_mfma_f32_16x16x32_bf16 v[60:63], v[16:19], v[96:99], 0
  v_mfma_f32_16x16x32_bf16 v[56:59], v[12:15], v[100:103], v[56:59]
  v_mfma_f32_16x16x32_bf16 v[60:63], v[20:23], v[100:103], v[60:63]
  s_barrier
  s_setprio 3
  ds_read_b32 v120, v137 offset:47616
  ds_read_b128 v[148:151], v7
  s_waitcnt lgkmcnt(1)
  v_lshrrev_b32 v159, 17, v120
  v_add_u32 v121, v159, v112
  v_and_b32 v120, 0x1ffff, v120
  v_lshrrev_b32 v121, 1, v121
  v_mad_u32_u24 v154, v121, v113, v120
  ds_read_u16 v124, v154
  v_pk_mul_f32 v[72:73], v[72:73], s[66:67]
  v_pk_mul_f32 v[74:75], v[74:75], s[66:67]
  ds_write_b128 v1, v[72:75] offset:0
  v_pk_mul_f32 v[76:77], v[76:77], s[66:67]
  v_pk_mul_f32 v[78:79], v[78:79], s[66:67]
  ds_write_b128 v1, v[76:79] offset:64
  v_pk_mul_f32 v[80:81], v[80:81], s[66:67]
  v_pk_mul_f32 v[82:83], v[82:83], s[66:67]
  ds_write_b128 v1, v[80:83] offset:4352
  v_pk_mul_f32 v[84:85], v[84:85], s[66:67]
  v_pk_mul_f32 v[86:87], v[86:87], s[66:67]
  ds_write_b128 v1, v[84:87] offset:4416
  v_pk_mul_f32 v[64:65], v[64:65], s[66:67]
  v_pk_mul_f32 v[66:67], v[66:67], s[66:67]
  ds_write_b128 v1, v[64:67] offset:8704
  v_pk_mul_f32 v[68:69], v[68:69], s[66:67]
  v_pk_mul_f32 v[70:71], v[70:71], s[66:67]
  ds_write_b128 v1, v[68:71] offset:8768
  s_waitcnt lgkmcnt(6)
  buffer_load_dwordx4 v[24:27], v[124:125], s[28:31], 0 idxen offen
  buffer_load_dwordx4 v[28:31], v[124:125], s[28:31], 0 idxen offen offset:64
  s_cmp_gt_u32 s72, 1
  s_cbranch_scc1 K2_NQ2
  v_pk_mul_f32 v[56:57], v[56:57], s[66:67]
  v_pk_mul_f32 v[58:59], v[58:59], s[66:67]
  ds_write_b128 v1, v[56:59] offset:13056
  v_pk_mul_f32 v[60:61], v[60:61], s[66:67]
  v_pk_mul_f32 v[62:63], v[62:63], s[66:67]
  ds_write_b128 v1, v[60:63] offset:13120
  s_branch K2_NQ2
K2_G2:
  s_waitcnt lgkmcnt(0)
K2_G2B:
  s_barrier
  ds_read_b32 v120, v137 offset:47616
  ds_read_b128 v[148:151], v7
  s_waitcnt lgkmcnt(1)
  v_lshrrev_b32 v159, 17, v120
  v_add_u32 v121, v159, v112
  v_and_b32 v120, 0x1ffff, v120
  v_lshrrev_b32 v121, 1, v121
  v_mad_u32_u24 v154, v121, v113, v120
  ds_read_u16 v124, v154
  s_waitcnt lgkmcnt(0)
  buffer_load_dwordx4 v[24:27], v[124:125], s[28:31], 0 idxen offen
  buffer_load_dwordx4 v[28:31], v[124:125], s[28:31], 0 idxen offen offset:64
  s_branch K2_NQ2
K2_CT:
  s_lshl_b32 s60, s3, 12
  s_add_u32 m0, s60, 72704
  s_add_u32 s60, s60, 3679232
  s_mov_b32 s61, 89552
  s_waitcnt vmcnt(6)
  v_cmp_ne_u32 s[40:41], -1, v104
  v_cmp_ne_u32 s[42:43], -1, v105
  v_cmp_ne_u32 s[44:45], -1, v106
  v_cmp_ne_u32 s[46:47], -1, v107
  v_cmp_eq_u32 vcc, v76, v104
  s_mov_b64 exec, s[40:41]
  buffer_load_dwordx4 v[56:59], v3, s[24:27], s62 offen offset:0
  s_mov_b64 exec, s[42:43]
  buffer_load_dwordx4 v[60:63], v3, s[24:27], s62 offen offset:16
  s_mov_b64 exec, s[44:45]
  buffer_load_dwordx4 v[64:67], v3, s[24:27], s62 offen offset:32
  s_mov_b64 exec, s[46:47]
  buffer_load_dwordx4 v[68:71], v3, s[24:27], s62 offen offset:48
  s_mov_b64 exec, -1
  s_cmp_eq_u64 s[40:41], 0
  s_cbranch_scc1 K2_TS0
  v_mov_b32 v88, -1
  v_mov_b32 v89, -1
  v_mov_b32 v90, -1
  v_mov_b32 v91, -1
  v_lshlrev_b32_sdwa v32, 2, v104 dst_sel:DWORD dst_unused:UNUSED_PAD src0_sel:DWORD src1_sel:BYTE_0
  v_lshlrev_b32_sdwa v33, 2, v104 dst_sel:DWORD dst_unused:UNUSED_PAD src0_sel:DWORD src1_sel:BYTE_1
  v_lshlrev_b32_sdwa v34, 2, v104 dst_sel:DWORD dst_unused:UNUSED_PAD src0_sel:DWORD src1_sel:BYTE_2
  v_lshlrev_b32_sdwa v35, 2, v104 dst_sel:DWORD dst_unused:UNUSED_PAD src0_sel:DWORD src1_sel:BYTE_3
  v_cmp_gt_u32 s[48:49], s64, v32
  v_cmp_gt_u32 s[50:51], s64, v33
  v_cmp_gt_u32 s[52:53], s64, v34
  v_cmp_gt_u32 s[54:55], s64, v35
  s_mov_b64 exec, s[48:49]
  ds_add_rtn_u32 v88, v32, v5 offset:47104
  s_mov_b64 exec, s[50:51]
  ds_add_rtn_u32 v89, v33, v5 offset:47104
  s_mov_b64 exec, s[52:53]
  ds_add_rtn_u32 v90, v34, v5 offset:47104
  s_mov_b64 exec, s[54:55]
  ds_add_rtn_u32 v91, v35, v5 offset:47104
  s_mov_b64 exec, -1
  s_bitset1_b32 s70, 0
K2_TS0:
  s_cmp_eq_u64 s[42:43], 0
  s_cbranch_scc1 K2_TS1
  v_mov_b32 v92, -1
  v_mov_b32 v93, -1
  v_mov_b32 v94, -1
  v_mov_b32 v95, -1
  v_lshlrev_b32_sdwa v36, 2, v105 dst_sel:DWORD dst_unused:UNUSED_PAD src0_sel:DWORD src1_sel:BYTE_0
  v_lshlrev_b32_sdwa v37, 2, v105 dst_sel:DWORD dst_unused:UNUSED_PAD src0_sel:DWORD src1_sel:BYTE_1
  v_lshlrev_b32_sdwa v38, 2, v105 dst_sel:DWORD dst_unused:UNUSED_PAD src0_sel:DWORD src1_sel:BYTE_2
  v_lshlrev_b32_sdwa v39, 2, v105 dst_sel:DWORD dst_unused:UNUSED_PAD src0_sel:DWORD src1_sel:BYTE_3
  v_cmp_gt_u32 s[48:49], s64, v36
  v_cmp_gt_u32 s[50:51], s64, v37
  v_cmp_gt_u32 s[52:53], s64, v38
  v_cmp_gt_u32 s[54:55], s64, v39
  s_mov_b64 exec, s[48:49]
  ds_add_rtn_u32 v92, v36, v5 offset:47104
  s_mov_b64 exec, s[50:51]
  ds_add_rtn_u32 v93, v37, v5 offset:47104
  s_mov_b64 exec, s[52:53]
  ds_add_rtn_u32 v94, v38, v5 offset:47104
  s_mov_b64 exec, s[54:55]
  ds_add_rtn_u32 v95, v39, v5 offset:47104
  s_mov_b64 exec, -1
  s_bitset1_b32 s70, 1
K2_TS1:
  s_cmp_eq_u64 s[44:45], 0
  s_cbranch_scc1 K2_TS2
  v_mov_b32 v96, -1
  v_mov_b32 v97, -1
  v_mov_b32 v98, -1
  v_mov_b32 v99, -1
  v_lshlrev_b32_sdwa v40, 2, v106 dst_sel:DWORD dst_unused:UNUSED_PAD src0_sel:DWORD src1_sel:BYTE_0
  v_lshlrev_b32_sdwa v41, 2, v106 dst_sel:DWORD dst_unused:UNUSED_PAD src0_sel:DWORD src1_sel:BYTE_1
  v_lshlrev_b32_sdwa v42, 2, v106 dst_sel:DWORD dst_unused:UNUSED_PAD src0_sel:DWORD src1_sel:BYTE_2
  v_lshlrev_b32_sdwa v43, 2, v106 dst_sel:DWORD dst_unused:UNUSED_PAD src0_sel:DWORD src1_sel:BYTE_3
  v_cmp_gt_u32 s[48:49], s64, v40
  v_cmp_gt_u32 s[50:51], s64, v41
  v_cmp_gt_u32 s[52:53], s64, v42
  v_cmp_gt_u32 s[54:55], s64, v43
  s_mov_b64 exec, s[48:49]
  ds_add_rtn_u32 v96, v40, v5 offset:47104
  s_mov_b64 exec, s[50:51]
  ds_add_rtn_u32 v97, v41, v5 offset:47104
  s_mov_b64 exec, s[52:53]
  ds_add_rtn_u32 v98, v42, v5 offset:47104
  s_mov_b64 exec, s[54:55]
  ds_add_rtn_u32 v99, v43, v5 offset:47104
  s_mov_b64 exec, -1
  s_bitset1_b32 s70, 2
K2_TS2:
  s_cmp_eq_u64 s[46:47], 0
  s_cbranch_scc1 K2_TS3
  s_waitcnt lgkmcnt(8)
  v_mov_b32 v100, -1
  v_mov_b32 v101, -1
  v_mov_b32 v102, -1
  v_mov_b32 v103, -1
  v_lshlrev_b32_sdwa v44, 2, v107 dst_sel:DWORD dst_unused:UNUSED_PAD src0_sel:DWORD src1_sel:BYTE_0
  v_lshlrev_b32_sdwa v45, 2, v107 dst_sel:DWORD dst_unused:UNUSED_PAD src0_sel:DWORD src1_sel:BYTE_1
  v_lshlrev_b32_sdwa v46, 2, v107 dst_sel:DWORD dst_unused:UNUSED_PAD src0_sel:DWORD src1_sel:BYTE_2
  v_lshlrev_b32_sdwa v47, 2, v107 dst_sel:DWORD dst_unused:UNUSED_PAD src0_sel:DWORD src1_sel:BYTE_3
  v_cmp_gt_u32 s[48:49], s64, v44
  v_cmp_gt_u32 s[50:51], s64, v45
  v_cmp_gt_u32 s[52:53], s64, v46
  v_cmp_gt_u32 s[54:55], s64, v47
  s_mov_b64 exec, s[48:49]
  ds_add_rtn_u32 v100, v44, v5 offset:47104
  s_mov_b64 exec, s[50:51]
  ds_add_rtn_u32 v101, v45, v5 offset:47104
  s_mov_b64 exec, s[52:53]
  ds_add_rtn_u32 v102, v46, v5 offset:47104
  s_mov_b64 exec, s[54:55]
  ds_add_rtn_u32 v103, v47, v5 offset:47104
  s_mov_b64 exec, -1
  s_bitset1_b32 s70, 3
K2_TS3:
  buffer_load_dwordx4 v6, s[24:27], s60 offen offset:0 lds
  buffer_load_dwordx4 v6, s[24:27], s60 offen offset:1024 lds
  buffer_load_dwordx4 v6, s[24:27], s60 offen offset:2048 lds
  buffer_load_dwordx4 v6, s[24:27], s60 offen offset:3072 lds
  s_cbranch_vccnz K2_MARK
K2_MR:
  s_waitcnt lgkmcnt(0)
  s_waitcnt vmcnt(8)
  s_barrier
K2_AB1T:
  v_and_b32 v12, 0xfc, v16
  ds_read2st64_b32 v[8:9], v12 offset0:182 offset1:183
  ds_read2st64_b32 v[10:11], v12 offset0:184 offset1:185
  s_setprio 3
  s_mov_b32 s56, -1
  s_mov_b32 s57, 3
  s_mov_b32 s52, s70
  s_waitcnt lgkmcnt(0)
  v_readlane_b32 s23, v9, 48
  v_sub_u32 v8, v8, v17
  v_sub_u32 v9, v9, v18
  v_add_u32 v8, v8, v10
  v_add_u32 v9, v9, v11
  s_andn2_b32 s23, s23, s68
  s_cbranch_scc1 K2_RESCAN
  s_cmp_lg_u32 s3, 0
  s_cbranch_scc1 K2_TF
  v_med3_u32 v10, v8, v19, v20
  v_add_u32 v12, s61, v10
  ds_add_rtn_u32 v12, v12, v22
  s_mov_b64 exec, s[56:57]
  v_med3_u32 v11, v9, v19, v20
  v_add_u32 v13, s61, v11
  ds_add_rtn_u32 v13, v13, v22
  v_cmp_gt_u32 s[40:41], v9, v20
  s_mov_b64 exec, -1
  ds_read_b32 v14, v21
  v_cmp_gt_u32 vcc, v8, v20
  v_min_u32 v8, v8, v20
  v_lshrrev_b32 v8, 2, v8
  v_mul_u32_u24 v8, 509, v8
  v_lshrrev_b32 v8, 16, v8
  v_max_u32 v10, 9, v8
  v_sub_u32 v10, 72, v10
  v_lshlrev_b32 v10, 2, v10
  v_lshl_or_b32 v8, v8, 17, v17
  v_min_u32 v9, v9, v20
  v_lshrrev_b32 v9, 2, v9
  v_mul_u32_u24 v9, 509, v9
  v_lshrrev_b32 v9, 16, v9
  v_max_u32 v11, 9, v9
  v_sub_u32 v11, 72, v11
  v_lshlrev_b32 v11, 2, v11
  v_lshl_or_b32 v9, v9, 17, v18
  s_or_b64 vcc, vcc, s[40:41]
  s_waitcnt lgkmcnt(0)
  v_add_u32_dpp v15, v14, v14 row_shr:1 row_mask:0xf bank_mask:0xf bound_ctrl:0
  s_nop 1
  v_add_u32_dpp v15, v15, v15 row_shr:2 row_mask:0xf bank_mask:0xf bound_ctrl:0
  s_nop 1
  v_add_u32_dpp v15, v15, v15 row_shr:4 row_mask:0xf bank_mask:0xf bound_ctrl:0
  s_nop 1
  v_add_u32_dpp v15, v15, v15 row_shr:8 row_mask:0xf bank_mask:0xf bound_ctrl:0
  s_nop 1
  v_add_u32_dpp v15, v15, v15 row_bcast:15 row_mask:0xa bank_mask:0xf
  s_nop 1
  v_add_u32_dpp v15, v15, v15 row_bcast:31 row_mask:0xc bank_mask:0xf
  v_sub_u32 v15, v15, v14
  ds_bpermute_b32 v10, v10, v15
  ds_bpermute_b32 v11, v11, v15
  v_mov_b32 v14, 0
  s_waitcnt lgkmcnt(1)
  v_add_u32 v10, v10, v12
  ds_write_b32 v10, v8 offset:47616
  s_waitcnt lgkmcnt(1)
  s_mov_b64 exec, s[56:57]
  v_add_u32 v11, v11, v13
  ds_write_b32 v11, v9 offset:47616
  s_mov_b64 exec, -1
  s_cbranch_vccz K2_TW
  ds_write_b32 v14, v5 offset:47044
  s_branch K2_TW
K2_TF:
  s_bitcmp0_b32 s70, 0
  s_cbranch_scc1 K2_TQ0
  ds_read_b32 v72, v32 offset:46592
  ds_read_b32 v73, v33 offset:46592
  ds_read_b32 v74, v34 offset:46592
  ds_read_b32 v75, v35 offset:46592
K2_TQ0:
  s_bitcmp0_b32 s70, 1
  s_cbranch_scc1 K2_TQ1
  ds_read_b32 v76, v36 offset:46592
  ds_read_b32 v77, v37 offset:46592
  ds_read_b32 v78, v38 offset:46592
  ds_read_b32 v79, v39 offset:46592
K2_TQ1:
  s_bitcmp0_b32 s70, 2
  s_cbranch_scc1 K2_TQ2
  ds_read_b32 v80, v40 offset:46592
  ds_read_b32 v81, v41 offset:46592
  ds_read_b32 v82, v42 offset:46592
  ds_read_b32 v83, v43 offset:46592
K2_TQ2:
  s_bitcmp0_b32 s70, 3
  s_cbranch_scc1 K2_TQ3
  s_waitcnt lgkmcnt(8)
  ds_read_b32 v84, v44 offset:46592
  ds_read_b32 v85, v45 offset:46592
  ds_read_b32 v86, v46 offset:46592
  ds_read_b32 v87, v47 offset:46592
K2_TQ3:
  s_mov_b32 s52, 0
  s_waitcnt lgkmcnt(0)
  s_bitcmp0_b32 s70, 0
  s_cbranch_scc1 K2_TP0
  v_add_u32 v88, v88, v72 clamp
  v_min_u32 v88, s65, v88
  v_add_u32 v89, v89, v73 clamp
  v_min_u32 v89, s65, v89
  v_add_u32 v90, v90, v74 clamp
  v_min_u32 v90, s65, v90
  v_add_u32 v91, v91, v75 clamp
  v_min_u32 v91, s65, v91
K2_TP0:
  s_bitcmp0_b32 s70, 1
  s_cbranch_scc1 K2_TP1
  v_add_u32 v92, v92, v76 clamp
  v_min_u32 v92, s65, v92
  v_add_u32 v93, v93, v77 clamp
  v_min_u32 v93, s65, v93
  v_add_u32 v94, v94, v78 clamp
  v_min_u32 v94, s65, v94
  v_add_u32 v95, v95, v79 clamp
  v_min_u32 v95, s65, v95
K2_TP1:
  s_bitcmp0_b32 s70, 2
  s_cbranch_scc1 K2_TP2
  v_add_u32 v96, v96, v80 clamp
  v_min_u32 v96, s65, v96
  v_add_u32 v97, v97, v81 clamp
  v_min_u32 v97, s65, v97
  v_add_u32 v98, v98, v82 clamp
  v_min_u32 v98, s65, v98
  v_add_u32 v99, v99, v83 clamp
  v_min_u32 v99, s65, v99
K2_TP2:
  s_bitcmp0_b32 s70, 3
  s_cbranch_scc1 K2_TP3
  v_add_u32 v100, v100, v84 clamp
  v_min_u32 v100, s65, v100
  v_add_u32 v101, v101, v85 clamp
  v_min_u32 v101, s65, v101
  v_add_u32 v102, v102, v86 clamp
  v_min_u32 v102, s65, v102
  v_add_u32 v103, v103, v87 clamp
  v_min_u32 v103, s65, v103
K2_TP3:
K2_TW:
K2_CWR:
  v_cmp_eq_u32 s[44:45], 0, v4
  v_cmp_eq_u32 s[46:47], 1, v4
  v_cmp_eq_u32 s[48:49], 2, v4
  v_cmp_eq_u32 s[50:51], 3, v4
  v_add_u32 v7, 71680, v6
  s_waitcnt lgkmcnt(0)
  s_barrier
  ds_read_b32 v120, v137 offset:47616
  ds_read_b128 v[148:151], v7
  s_waitcnt lgkmcnt(1)
  v_lshrrev_b32 v159, 17, v120
  v_add_u32 v121, v159, v112
  v_and_b32 v120, 0x1ffff, v120
  v_lshrrev_b32 v121, 1, v121
  v_mad_u32_u24 v154, v121, v113, v120
  ds_read_u16 v124, v154
  s_waitcnt lgkmcnt(0)
  buffer_load_dwordx4 v[24:27], v[124:125], s[28:31], 0 idxen offen
  buffer_load_dwordx4 v[28:31], v[124:125], s[28:31], 0 idxen offen offset:64
  s_cmp_eq_u32 s52, 0
  s_cbranch_scc1 K2_TR3
  s_bitcmp0_b32 s70, 0
  s_cbranch_scc1 K2_TR0
  ds_read_b32 v48, v32 offset:46592
  ds_read_b32 v49, v33 offset:46592
  ds_read_b32 v50, v34 offset:46592
  ds_read_b32 v51, v35 offset:46592
  s_waitcnt lgkmcnt(3)
  v_add_u32 v88, v88, v48 clamp
  v_min_u32 v88, s65, v88
  s_waitcnt lgkmcnt(2)
  v_add_u32 v89, v89, v49 clamp
  v_min_u32 v89, s65, v89
  s_waitcnt lgkmcnt(1)
  v_add_u32 v90, v90, v50 clamp
  v_min_u32 v90, s65, v90
  s_waitcnt lgkmcnt(0)
  v_add_u32 v91, v91, v51 clamp
  v_min_u32 v91, s65, v91
K2_TR0:
  s_bitcmp0_b32 s70, 1
  s_cbranch_scc1 K2_TR1
  ds_read_b32 v48, v36 offset:46592
  ds_read_b32 v49, v37 offset:46592
  ds_read_b32 v50, v38 offset:46592
  ds_read_b32 v51, v39 offset:46592
  s_waitcnt lgkmcnt(3)
  v_add_u32 v92, v92, v48 clamp
  v_min_u32 v92, s65, v92
  s_waitcnt lgkmcnt(2)
  v_add_u32 v93, v93, v49 clamp
  v_min_u32 v93, s65, v93
  s_waitcnt lgkmcnt(1)
  v_add_u32 v94, v94, v50 clamp
  v_min_u32 v94, s65, v94
  s_waitcnt lgkmcnt(0)
  v_add_u32 v95, v95, v51 clamp
  v_min_u32 v95, s65, v95
K2_TR1:
  s_bitcmp0_b32 s70, 2
  s_cbranch_scc1 K2_TR2
  ds_read_b32 v48, v40 offset:46592
  ds_read_b32 v49, v41 offset:46592
  ds_read_b32 v50, v42 offset:46592
  ds_read_b32 v51, v43 offset:46592
  s_waitcnt lgkmcnt(3)
  v_add_u32 v96, v96, v48 clamp
  v_min_u32 v96, s65, v96
  s_waitcnt lgkmcnt(2)
  v_add_u32 v97, v97, v49 clamp
  v_min_u32 v97, s65, v97
  s_waitcnt lgkmcnt(1)
  v_add_u32 v98, v98, v50 clamp
  v_min_u32 v98, s65, v98
  s_waitcnt lgkmcnt(0)
  v_add_u32 v99, v99, v51 clamp
  v_min_u32 v99, s65, v99
K2_TR2:
  s_bitcmp0_b32 s70, 3
  s_cbranch_scc1 K2_TR3
  ds_read_b32 v48, v44 offset:46592
  ds_read_b32 v49, v45 offset:46592
  ds_read_b32 v50, v46 offset:46592
  ds_read_b32 v51, v47 offset:46592
  s_waitcnt lgkmcnt(3)
  v_add_u32 v100, v100, v48 clamp
  v_min_u32 v100, s65, v100
  s_waitcnt lgkmcnt(2)
  v_add_u32 v101, v101, v49 clamp
  v_min_u32 v101, s65, v101
  s_waitcnt lgkmcnt(1)
  v_add_u32 v102, v102, v50 clamp
  v_min_u32 v102, s65, v102
  s_waitcnt lgkmcnt(0)
  v_add_u32 v103, v103, v51 clamp
  v_min_u32 v103, s65, v103
K2_TR3:
  s_waitcnt vmcnt(6)
  s_bitcmp0_b32 s70, 0
  s_cbranch_scc1 K2_TW0
  ds_write_b32 v88, v56
  ds_write_b32 v89, v57
  ds_write_b32 v90, v58
  ds_write_b32 v91, v59
K2_TW0:
  s_bitcmp0_b32 s70, 1
  s_cbranch_scc1 K2_TW1
  ds_write_b32 v92, v60
  ds_write_b32 v93, v61
  ds_write_b32 v94, v62
  ds_write_b32 v95, v63
K2_TW1:
  s_bitcmp0_b32 s70, 2
  s_cbranch_scc1 K2_TW2
  ds_write_b32 v96, v64
  ds_write_b32 v97, v65
  ds_write_b32 v98, v66
  ds_write_b32 v99, v67
K2_TW2:
  s_bitcmp0_b32 s70, 3
  s_cbranch_scc1 K2_TW3
  s_waitcnt lgkmcnt(4)
  ds_write_b32 v100, v68
  ds_write_b32 v101, v69
  ds_write_b32 v102, v70
  ds_write_b32 v103, v71
K2_TW3:
K2_NQ2:
  v_mov_b32 v121, 68
  v_mad_u32_u24 v122, v120, v121, v115
  v_mov_b32 v136, 0
  v_mov_b32 v137, 0
  v_mov_b32 v138, 0
  v_mov_b32 v139, 0
  v_add_u32 v159, v159, v114
  v_lshrrev_b32 v159, v112, v159
  v_mad_u32_u24 v160, v120, 36, v116
  s_nop 0
  v_max_u32_dpp v121, v159, v159 row_shr:4 row_mask:0xf bank_mask:0xf bound_ctrl:0
  v_min_u32_dpp v123, v159, v159 row_shr:4 row_mask:0xf bank_mask:0xf bound_ctrl:0
  s_and_b32 s23, s3, 1
  s_lshl_b32 s23, s23, 13
  v_max_u32_dpp v121, v121, v121 row_shr:8 row_mask:0xf bank_mask:0xf bound_ctrl:0
  v_min_u32_dpp v123, v123, v123 row_shr:8 row_mask:0xf bank_mask:0xf bound_ctrl:0
  s_add_u32 s23, s23, 1024
  v_add_u32 v7, s23, v7
  v_readlane_b32 s69, v121, 15
  v_readlane_b32 s70, v121, 31
  v_readlane_b32 s64, v121, 47
  v_readlane_b32 s65, v121, 63
  s_max_u32 s69, s69, s70
  s_max_u32 s64, s64, s65
  s_max_u32 s69, s69, s64
  v_readlane_b32 s56, v123, 15
  v_readlane_b32 s70, v123, 31
  v_readlane_b32 s64, v123, 47
  v_readlane_b32 s65, v123, 63
  s_min_u32 s56, s56, s70
  s_min_u32 s64, s64, s65
  s_min_u32 s56, s56, s64
  s_sub_u32 s64, s69, 3
  s_max_i32 s64, s64, 0
  s_min_u32 s56, s56, s64
  s_mov_b32 s70, 0
  s_waitcnt vmcnt(2) lgkmcnt(0)
  s_barrier
  ds_read_u16 v123, v154
  ds_read_u16 v126, v154 offset:516
  ds_read_u16 v128, v154 offset:1032
  ds_read_b128 v[8:11], v122 offset:0
  ds_read_b128 v[12:15], v122 offset:16
  ds_read_b128 v[16:19], v122 offset:32
  ds_read_b128 v[20:23], v122 offset:48
  s_mov_b64 exec, s[44:45]
  ds_read_b32 v136, v154 offset:0
  s_mov_b64 exec, s[46:47]
  ds_read_b32 v137, v154 offset:0
  s_mov_b64 exec, s[48:49]
  ds_read_b32 v138, v154 offset:0
  s_mov_b64 exec, s[50:51]
  ds_read_b32 v139, v154 offset:0
  s_mov_b64 exec, -1
  ds_read_u16 v130, v154 offset:1548
  ds_read_u16 v152, v154 offset:2064
  s_waitcnt lgkmcnt(11)
  v_cmp_ne_u32 vcc, v123, v124
  s_cbranch_vccnz K2_G0R
K2_G0D:
  buffer_load_dwordx4 v[32:35], v[126:127], s[28:31], 0 idxen offen
  buffer_load_dwordx4 v[36:39], v[126:127], s[28:31], 0 idxen offen offset:64
  s_cmp_eq_u32 s56, 0
  s_cbranch_scc1 K2_GEN
  s_setprio 3
  s_waitcnt vmcnt(2) lgkmcnt(0)
  v_mfma_f32_4x4x4_16b_bf16 v[88:91], v[140:141], v[24:25], v[8:11]
  v_mfma_f32_4x4x4_16b_bf16 v[92:95], v[140:141], v[26:27], v[12:15]
  v_mfma_f32_4x4x4_16b_bf16 v[96:99], v[140:141], v[28:29], v[16:19]
  v_mfma_f32_4x4x4_16b_bf16 v[100:103], v[140:141], v[30:31], v[20:23]
  s_nop 3
  v_mfma_f32_32x32x16_bf16 v[88:103], v[148:151], v[136:139], v[88:103]
  buffer_load_dwordx4 v[24:27], v[128:129], s[28:31], 0 idxen offen
  buffer_load_dwordx4 v[28:31], v[128:129], s[28:31], 0 idxen offen offset:64
  s_mov_b64 exec, s[44:45]
  ds_read_b32 v136, v154 offset:516
  s_mov_b64 exec, s[46:47]
  ds_read_b32 v137, v154 offset:516
  s_mov_b64 exec, s[48:49]
  ds_read_b32 v138, v154 offset:516
  s_mov_b64 exec, s[50:51]
  ds_read_b32 v139, v154 offset:516
  s_mov_b64 exec, -1
  s_nop 0
  v_exp_f32 v104, v88
  v_exp_f32 v105, v89
  v_exp_f32 v106, v90
  v_exp_f32 v107, v91
  s_waitcnt lgkmcnt(0)
  v_mfma_f32_32x32x16_bf16 v[72:87], v[148:151], v[136:139], v[8:23]
  v_exp_f32 v108, v92
  v_exp_f32 v109, v93
  v_exp_f32 v110, v94
  v_exp_f32 v111, v95
  v_exp_f32 v112, v96
  v_exp_f32 v113, v97
  v_exp_f32 v114, v98
  v_exp_f32 v115, v99
  v_exp_f32 v116, v100
  v_exp_f32 v117, v101
  v_exp_f32 v118, v102
  v_exp_f32 v119, v103
  s_mov_b64 exec, s[44:45]
  ds_read_b32 v136, v154 offset:1032
  s_mov_b64 exec, s[46:47]
  ds_read_b32 v137, v154 offset:1032
  s_mov_b64 exec, s[48:49]
  ds_read_b32 v138, v154 offset:1032
  s_mov_b64 exec, s[50:51]
  ds_read_b32 v139, v154 offset:1032
  s_mov_b64 exec, -1
  v_pk_add_f32 v[104:105], v[104:105], 1.0 op_sel_hi:[1,0]
  v_pk_add_f32 v[106:107], v[106:107], 1.0 op_sel_hi:[1,0]
  v_pk_add_f32 v[108:109], v[108:109], 1.0 op_sel_hi:[1,0]
  v_pk_add_f32 v[110:111], v[110:111], 1.0 op_sel_hi:[1,0]
  v_pk_add_f32 v[112:113], v[112:113], 1.0 op_sel_hi:[1,0]
  v_pk_add_f32 v[114:115], v[114:115], 1.0 op_sel_hi:[1,0]
  v_pk_add_f32 v[116:117], v[116:117], 1.0 op_sel_hi:[1,0]
  v_pk_add_f32 v[118:119], v[118:119], 1.0 op_sel_hi:[1,0]
  s_mov_b32 s70, 1
  s_waitcnt vmcnt(2)
  v_mfma_f32_4x4x4_16b_bf16 v[72:75], v[140:141], v[32:33], v[72:75]
  v_mfma_f32_4x4x4_16b_bf16 v[76:79], v[140:141], v[34:35], v[76:79]
  v_mfma_f32_4x4x4_16b_bf16 v[80:83], v[140:141], v[36:37], v[80:83]
  v_mfma_f32_4x4x4_16b_bf16 v[84:87], v[140:141], v[38:39], v[84:87]
  buffer_load_dwordx4 v[32:35], v[130:131], s[28:31], 0 idxen offen
  buffer_load_dwordx4 v[36:39], v[130:131], s[28:31], 0 idxen offen offset:64
  s_branch K2_PRI0
K2_GEN:
  v_mov_b32 v88, 0
  v_mov_b32 v104, 1.0
  v_mov_b32 v89, 0
  v_mov_b32 v105, 1.0
  v_mov_b32 v90, 0
  v_mov_b32 v106, 1.0
  v_mov_b32 v91, 0
  v_mov_b32 v107, 1.0
  v_mov_b32 v92, 0
  v_mov_b32 v108, 1.0
  v_mov_b32 v93, 0
  v_mov_b32 v109, 1.0
  v_mov_b32 v94, 0
  v_mov_b32 v110, 1.0
  v_mov_b32 v95, 0
  v_mov_b32 v111, 1.0
  v_mov_b32 v96, 0
  v_mov_b32 v112, 1.0
  v_mov_b32 v97, 0
  v_mov_b32 v113, 1.0
  v_mov_b32 v98, 0
  v_mov_b32 v114, 1.0
  v_mov_b32 v99, 0
  v_mov_b32 v115, 1.0
  v_mov_b32 v100, 0
  v_mov_b32 v116, 1.0
  v_mov_b32 v101, 0
  v_mov_b32 v117, 1.0
  v_mov_b32 v102, 0
  v_mov_b32 v118, 1.0
  v_mov_b32 v103, 0
  v_mov_b32 v119, 1.0
  s_waitcnt lgkmcnt(0)
  v_mov_b32 v152, v130
  s_cmp_eq_u32 s69, 0
  s_cbranch_scc1 K2_DONE0
  s_waitcnt vmcnt(2) lgkmcnt(0)
  v_mfma_f32_4x4x4_16b_bf16 v[56:59], v[140:141], v[24:25], v[8:11]
  v_mfma_f32_4x4x4_16b_bf16 v[60:63], v[140:141], v[26:27], v[12:15]
  v_mfma_f32_4x4x4_16b_bf16 v[64:67], v[140:141], v[28:29], v[16:19]
  v_mfma_f32_4x4x4_16b_bf16 v[68:71], v[140:141], v[30:31], v[20:23]
  s_nop 3
  v_mfma_f32_32x32x16_bf16 v[56:71], v[148:151], v[136:139], v[56:71]
  buffer_load_dwordx4 v[24:27], v[128:129], s[28:31], 0 idxen offen
  buffer_load_dwordx4 v[28:31], v[128:129], s[28:31], 0 idxen offen offset:64
  s_mov_b64 exec, s[44:45]
  ds_read_b32 v136, v154 offset:516
  s_mov_b64 exec, s[46:47]
  ds_read_b32 v137, v154 offset:516
  s_mov_b64 exec, s[48:49]
  ds_read_b32 v138, v154 offset:516
  s_mov_b64 exec, s[50:51]
  ds_read_b32 v139, v154 offset:516
  s_mov_b64 exec, -1
  s_nop 3
  s_branch K2_PRI1
.p2align 6
K2_L0:
  s_waitcnt lgkmcnt(0)
  v_mfma_f32_32x32x16_bf16 v[72:87], v[148:151], v[136:139], v[8:23]
  v_exp_f32 v120, v56
  v_exp_f32 v121, v57
  v_exp_f32 v122, v58
  v_exp_f32 v123, v59
  v_exp_f32 v124, v60
  v_exp_f32 v125, v61
  v_exp_f32 v126, v62
  v_exp_f32 v127, v63
  v_exp_f32 v128, v64
  v_exp_f32 v129, v65
  s_waitcnt vmcnt(2)
  v_mfma_f32_4x4x4_16b_bf16 v[72:75], v[140:141], v[32:33], v[72:75]
  v_exp_f32 v130, v66
  v_mfma_f32_4x4x4_16b_bf16 v[76:79], v[140:141], v[34:35], v[76:79]
  v_exp_f32 v131, v67
  v_mfma_f32_4x4x4_16b_bf16 v[80:83], v[140:141], v[36:37], v[80:83]
  v_exp_f32 v132, v68
  v_mfma_f32_4x4x4_16b_bf16 v[84:87], v[140:141], v[38:39], v[84:87]
  v_exp_f32 v133, v69
  v_exp_f32 v134, v70
  v_exp_f32 v135, v71
  buffer_load_dwordx4 v[32:35], v[152:153], s[28:31], 0 idxen offen
  buffer_load_dwordx4 v[36:39], v[152:153], s[28:31], 0 idxen offen offset:64
  ds_read_u16 v152, v154 offset:2064
  s_mov_b64 exec, s[44:45]
  ds_read_b32 v136, v154 offset:1032
  s_mov_b64 exec, s[46:47]
  ds_read_b32 v137, v154 offset:1032
  s_mov_b64 exec, s[48:49]
  ds_read_b32 v138, v154 offset:1032
  s_mov_b64 exec, s[50:51]
  ds_read_b32 v139, v154 offset:1032
  s_mov_b64 exec, -1
  v_pk_fma_f32 v[88:89], v[88:89], v[120:121], v[88:89]
  v_pk_fma_f32 v[90:91], v[90:91], v[122:123], v[90:91]
  v_pk_fma_f32 v[92:93], v[92:93], v[124:125], v[92:93]
  v_pk_fma_f32 v[94:95], v[94:95], v[126:127], v[94:95]
  v_pk_fma_f32 v[96:97], v[96:97], v[128:129], v[96:97]
  v_pk_fma_f32 v[98:99], v[98:99], v[130:131], v[98:99]
  v_pk_fma_f32 v[100:101], v[100:101], v[132:133], v[100:101]
  v_pk_fma_f32 v[102:103], v[102:103], v[134:135], v[102:103]
  v_pk_fma_f32 v[88:89], v[56:57], v[104:105], v[88:89]
  v_pk_fma_f32 v[90:91], v[58:59], v[106:107], v[90:91]
  v_pk_fma_f32 v[92:93], v[60:61], v[108:109], v[92:93]
  v_pk_fma_f32 v[94:95], v[62:63], v[110:111], v[94:95]
  v_pk_fma_f32 v[96:97], v[64:65], v[112:113], v[96:97]
  v_pk_fma_f32 v[98:99], v[66:67], v[114:115], v[98:99]
  v_pk_fma_f32 v[100:101], v[68:69], v[116:117], v[100:101]
  v_pk_fma_f32 v[102:103], v[70:71], v[118:119], v[102:103]
  v_pk_fma_f32 v[104:105], v[104:105], v[120:121], v[104:105]
  v_pk_fma_f32 v[106:107], v[106:107], v[122:123], v[106:107]
  v_pk_fma_f32 v[108:109], v[108:109], v[124:125], v[108:109]
  v_pk_fma_f32 v[110:111], v[110:111], v[126:127], v[110:111]
  v_pk_fma_f32 v[112:113], v[112:113], v[128:129], v[112:113]
  v_pk_fma_f32 v[114:115], v[114:115], v[130:131], v[114:115]
  v_pk_fma_f32 v[116:117], v[116:117], v[132:133], v[116:117]
  v_pk_fma_f32 v[118:119], v[118:119], v[134:135], v[118:119]
  s_add_u32 s70, s70, 1
  s_cmp_ge_u32 s70, s64
  s_cbranch_scc1 K2_PRI0
K2_L1:
  s_waitcnt lgkmcnt(0)
  v_mfma_f32_32x32x16_bf16 v[56:71], v[148:151], v[136:139], v[8:23]
  v_exp_f32 v120, v72
  v_exp_f32 v121, v73
  v_exp_f32 v122, v74
  v_exp_f32 v123, v75
  v_exp_f32 v124, v76
  v_exp_f32 v125, v77
  v_exp_f32 v126, v78
  v_exp_f32 v127, v79
  v_exp_f32 v128, v80
  v_exp_f32 v129, v81
  s_waitcnt vmcnt(2)
  v_mfma_f32_4x4x4_16b_bf16 v[56:59], v[140:141], v[24:25], v[56:59]
  v_exp_f32 v130, v82
  v_mfma_f32_4x4x4_16b_bf16 v[60:63], v[140:141], v[26:27], v[60:63]
  v_exp_f32 v131, v83
  v_mfma_f32_4x4x4_16b_bf16 v[64:67], v[140:141], v[28:29], v[64:67]
  v_exp_f32 v132, v84
  v_mfma_f32_4x4x4_16b_bf16 v[68:71], v[140:141], v[30:31], v[68:71]
  v_exp_f32 v133, v85
  v_exp_f32 v134, v86
  v_exp_f32 v135, v87
  buffer_load_dwordx4 v[24:27], v[152:153], s[28:31], 0 idxen offen
  buffer_load_dwordx4 v[28:31], v[152:153], s[28:31], 0 idxen offen offset:64
  ds_read_u16 v152, v154 offset:2580
  s_mov_b64 exec, s[44:45]
  ds_read_b32 v136, v154 offset:1548
  s_mov_b64 exec, s[46:47]
  ds_read_b32 v137, v154 offset:1548
  s_mov_b64 exec, s[48:49]
  ds_read_b32 v138, v154 offset:1548
  s_mov_b64 exec, s[50:51]
  ds_read_b32 v139, v154 offset:1548
  s_mov_b64 exec, -1
  v_pk_fma_f32 v[88:89], v[88:89], v[120:121], v[88:89]
  v_pk_fma_f32 v[90:91], v[90:91], v[122:123], v[90:91]
  v_pk_fma_f32 v[92:93], v[92:93], v[124:125], v[92:93]
  v_pk_fma_f32 v[94:95], v[94:95], v[126:127], v[94:95]
  v_pk_fma_f32 v[96:97], v[96:97], v[128:129], v[96:97]
  v_pk_fma_f32 v[98:99], v[98:99], v[130:131], v[98:99]
  v_pk_fma_f32 v[100:101], v[100:101], v[132:133], v[100:101]
  v_pk_fma_f32 v[102:103], v[102:103], v[134:135], v[102:103]
  v_pk_fma_f32 v[88:89], v[72:73], v[104:105], v[88:89]
  v_pk_fma_f32 v[90:91], v[74:75], v[106:107], v[90:91]
  v_pk_fma_f32 v[92:93], v[76:77], v[108:109], v[92:93]
  v_pk_fma_f32 v[94:95], v[78:79], v[110:111], v[94:95]
  v_pk_fma_f32 v[96:97], v[80:81], v[112:113], v[96:97]
  v_pk_fma_f32 v[98:99], v[82:83], v[114:115], v[98:99]
  v_pk_fma_f32 v[100:101], v[84:85], v[116:117], v[100:101]
  v_pk_fma_f32 v[102:103], v[86:87], v[118:119], v[102:103]
  v_pk_fma_f32 v[104:105], v[104:105], v[120:121], v[104:105]
  v_pk_fma_f32 v[106:107], v[106:107], v[122:123], v[106:107]
  v_pk_fma_f32 v[108:109], v[108:109], v[124:125], v[108:109]
  v_pk_fma_f32 v[110:111], v[110:111], v[126:127], v[110:111]
  v_pk_fma_f32 v[112:113], v[112:113], v[128:129], v[112:113]
  v_pk_fma_f32 v[114:115], v[114:115], v[130:131], v[114:115]
  v_pk_fma_f32 v[116:117], v[116:117], v[132:133], v[116:117]
  v_pk_fma_f32 v[118:119], v[118:119], v[134:135], v[118:119]
  s_add_u32 s70, s70, 1
  s_cmp_ge_u32 s70, s64
  v_add_u32 v154, 1032, v154
  s_cbranch_scc0 K2_L0
K2_PRI1:
  s_sub_u32 s65, s69, s70
  s_setprio 3
  s_sub_u32 s64, s69, 8
  s_cmp_gt_u32 s65, 8
  s_cbranch_scc1 K2_X1
  s_setprio 2
  s_sub_u32 s64, s69, 4
  s_cmp_gt_u32 s65, 4
  s_cbranch_scc1 K2_X1
  s_setprio 1
  s_sub_u32 s64, s69, 1
  s_cmp_gt_u32 s65, 1
  s_cbranch_scc1 K2_X1
  s_setprio 0
  s_mov_b32 s64, s69
  s_cmp_eq_u32 s65, 0
  s_cbranch_scc1 K2_DONEX
K2_X1:
  s_cmp_ge_u32 s70, s56
  s_cbranch_scc1 K2_M0
  s_min_u32 s64, s64, s56
  s_branch K2_L0
K2_PRI0:
  s_sub_u32 s65, s69, s70
  s_setprio 3
  s_sub_u32 s64, s69, 8
  s_cmp_gt_u32 s65, 8
  s_cbranch_scc1 K2_X0
  s_setprio 2
  s_sub_u32 s64, s69, 4
  s_cmp_gt_u32 s65, 4
  s_cbranch_scc1 K2_X0
  s_setprio 1
  s_sub_u32 s64, s69, 1
  s_cmp_gt_u32 s65, 1
  s_cbranch_scc1 K2_X0
  s_setprio 0
  s_mov_b32 s64, s69
  s_cmp_eq_u32 s65, 0
  s_cbranch_scc1 K2_DONEX
K2_X0:
  s_cmp_ge_u32 s70, s56
  s_cbranch_scc1 K2_M1
  s_min_u32 s64, s64, s56
  s_branch K2_L1
.p2align 6
K2_M0:
  v_cmpx_lt_u32 vcc, s70, v159
  s_sub_u32 s65, s69, s70
  v_exp_f32 v133, v69
  v_exp_f32 v134, v70
  v_exp_f32 v135, v71
  s_cmp_eq_u32 s65, 1
  s_cbranch_scc1 K2_MS0
  s_waitcnt lgkmcnt(0)
  v_mfma_f32_32x32x16_bf16 v[72:87], v[148:151], v[136:139], v[8:23]
  v_exp_f32 v120, v56
  v_exp_f32 v121, v57
  v_exp_f32 v122, v58
  v_exp_f32 v123, v59
  v_exp_f32 v124, v60
  v_exp_f32 v125, v61
  v_exp_f32 v126, v62
  s_waitcnt vmcnt(2)
  s_nop 1
  v_mfma_f32_4x4x4_16b_bf16 v[72:75], v[140:141], v[32:33], v[72:75]
  v_exp_f32 v127, v63
  v_mfma_f32_4x4x4_16b_bf16 v[76:79], v[140:141], v[34:35], v[76:79]
  v_exp_f32 v128, v64
  v_mfma_f32_4x4x4_16b_bf16 v[80:83], v[140:141], v[36:37], v[80:83]
  v_exp_f32 v129, v65
  v_mfma_f32_4x4x4_16b_bf16 v[84:87], v[140:141], v[38:39], v[84:87]
  v_exp_f32 v130, v66
  v_exp_f32 v131, v67
  v_exp_f32 v132, v68
  s_cmp_gt_u32 s65, 3
  s_cselect_b64 exec, vcc, 0
  buffer_load_dwordx4 v[32:35], v[152:153], s[28:31], 0 idxen offen
  buffer_load_dwordx4 v[36:39], v[152:153], s[28:31], 0 idxen offen offset:64
  ds_read_u16 v152, v154 offset:2064
  s_and_b64 exec, vcc, s[44:45]
  ds_read_b32 v136, v154 offset:1032
  s_and_b64 exec, vcc, s[46:47]
  ds_read_b32 v137, v154 offset:1032
  s_and_b64 exec, vcc, s[48:49]
  ds_read_b32 v138, v154 offset:1032
  s_and_b64 exec, vcc, s[50:51]
  ds_read_b32 v139, v154 offset:1032
  s_mov_b64 exec, vcc
  v_pk_fma_f32 v[88:89], v[88:89], v[120:121], v[88:89]
  v_pk_fma_f32 v[90:91], v[90:91], v[122:123], v[90:91]
  v_pk_fma_f32 v[92:93], v[92:93], v[124:125], v[92:93]
  v_pk_fma_f32 v[94:95], v[94:95], v[126:127], v[94:95]
  v_pk_fma_f32 v[96:97], v[96:97], v[128:129], v[96:97]
  v_pk_fma_f32 v[98:99], v[98:99], v[130:131], v[98:99]
  v_pk_fma_f32 v[100:101], v[100:101], v[132:133], v[100:101]
  v_pk_fma_f32 v[102:103], v[102:103], v[134:135], v[102:103]
  v_pk_fma_f32 v[88:89], v[56:57], v[104:105], v[88:89]
  v_pk_fma_f32 v[90:91], v[58:59], v[106:107], v[90:91]
  v_pk_fma_f32 v[92:93], v[60:61], v[108:109], v[92:93]
  v_pk_fma_f32 v[94:95], v[62:63], v[110:111], v[94:95]
  v_pk_fma_f32 v[96:97], v[64:65], v[112:113], v[96:97]
  v_pk_fma_f32 v[98:99], v[66:67], v[114:115], v[98:99]
  v_pk_fma_f32 v[100:101], v[68:69], v[116:117], v[100:101]
  v_pk_fma_f32 v[102:103], v[70:71], v[118:119], v[102:103]
  v_pk_fma_f32 v[104:105], v[104:105], v[120:121], v[104:105]
  v_pk_fma_f32 v[106:107], v[106:107], v[122:123], v[106:107]
  v_pk_fma_f32 v[108:109], v[108:109], v[124:125], v[108:109]
  v_pk_fma_f32 v[110:111], v[110:111], v[126:127], v[110:111]
  v_pk_fma_f32 v[112:113], v[112:113], v[128:129], v[112:113]
  v_pk_fma_f32 v[114:115], v[114:115], v[130:131], v[114:115]
  v_pk_fma_f32 v[116:117], v[116:117], v[132:133], v[116:117]
  v_pk_fma_f32 v[118:119], v[118:119], v[134:135], v[118:119]
  s_add_u32 s70, s70, 1
  s_cmp_ge_u32 s70, s64
  s_cbranch_scc1 K2_PRI0
K2_M1:
  v_cmpx_lt_u32 vcc, s70, v159
  s_sub_u32 s65, s69, s70
  v_exp_f32 v133, v85
  v_exp_f32 v134, v86
  v_exp_f32 v135, v87
  s_cmp_eq_u32 s65, 1
  s_cbranch_scc1 K2_MS1
  s_waitcnt lgkmcnt(0)
  v_mfma_f32_32x32x16_bf16 v[56:71], v[148:151], v[136:139], v[8:23]
  v_exp_f32 v120, v72
  v_exp_f32 v121, v73
  v_exp_f32 v122, v74
  v_exp_f32 v123, v75
  v_exp_f32 v124, v76
  v_exp_f32 v125, v77
  v_exp_f32 v126, v78
  s_waitcnt vmcnt(2)
  s_nop 1
  v_mfma_f32_4x4x4_16b_bf16 v[56:59], v[140:141], v[24:25], v[56:59]
  v_exp_f32 v127, v79
  v_mfma_f32_4x4x4_16b_bf16 v[60:63], v[140:141], v[26:27], v[60:63]
  v_exp_f32 v128, v80
  v_mfma_f32_4x4x4_16b_bf16 v[64:67], v[140:141], v[28:29], v[64:67]
  v_exp_f32 v129, v81
  v_mfma_f32_4x4x4_16b_bf16 v[68:71], v[140:141], v[30:31], v[68:71]
  v_exp_f32 v130, v82
  v_exp_f32 v131, v83
  v_exp_f32 v132, v84
  s_cmp_gt_u32 s65, 3
  s_cselect_b64 exec, vcc, 0
  buffer_load_dwordx4 v[24:27], v[152:153], s[28:31], 0 idxen offen
  buffer_load_dwordx4 v[28:31], v[152:153], s[28:31], 0 idxen offen offset:64
  ds_read_u16 v152, v154 offset:2580
  s_and_b64 exec, vcc, s[44:45]
  ds_read_b32 v136, v154 offset:1548
  s_and_b64 exec, vcc, s[46:47]
  ds_read_b32 v137, v154 offset:1548
  s_and_b64 exec, vcc, s[48:49]
  ds_read_b32 v138, v154 offset:1548
  s_and_b64 exec, vcc, s[50:51]
  ds_read_b32 v139, v154 offset:1548
  s_mov_b64 exec, vcc
  v_pk_fma_f32 v[88:89], v[88:89], v[120:121], v[88:89]
  v_pk_fma_f32 v[90:91], v[90:91], v[122:123], v[90:91]
  v_pk_fma_f32 v[92:93], v[92:93], v[124:125], v[92:93]
  v_pk_fma_f32 v[94:95], v[94:95], v[126:127], v[94:95]
  v_pk_fma_f32 v[96:97], v[96:97], v[128:129], v[96:97]
  v_pk_fma_f32 v[98:99], v[98:99], v[130:131], v[98:99]
  v_pk_fma_f32 v[100:101], v[100:101], v[132:133], v[100:101]
  v_pk_fma_f32 v[102:103], v[102:103], v[134:135], v[102:103]
  v_pk_fma_f32 v[88:89], v[72:73], v[104:105], v[88:89]
  v_pk_fma_f32 v[90:91], v[74:75], v[106:107], v[90:91]
  v_pk_fma_f32 v[92:93], v[76:77], v[108:109], v[92:93]
  v_pk_fma_f32 v[94:95], v[78:79], v[110:111], v[94:95]
  v_pk_fma_f32 v[96:97], v[80:81], v[112:113], v[96:97]
  v_pk_fma_f32 v[98:99], v[82:83], v[114:115], v[98:99]
  v_pk_fma_f32 v[100:101], v[84:85], v[116:117], v[100:101]
  v_pk_fma_f32 v[102:103], v[86:87], v[118:119], v[102:103]
  v_pk_fma_f32 v[104:105], v[104:105], v[120:121], v[104:105]
  v_pk_fma_f32 v[106:107], v[106:107], v[122:123], v[106:107]
  v_pk_fma_f32 v[108:109], v[108:109], v[124:125], v[108:109]
  v_pk_fma_f32 v[110:111], v[110:111], v[126:127], v[110:111]
  v_pk_fma_f32 v[112:113], v[112:113], v[128:129], v[112:113]
  v_pk_fma_f32 v[114:115], v[114:115], v[130:131], v[114:115]
  v_pk_fma_f32 v[116:117], v[116:117], v[132:133], v[116:117]
  v_pk_fma_f32 v[118:119], v[118:119], v[134:135], v[118:119]
  s_add_u32 s70, s70, 1
  s_cmp_ge_u32 s70, s64
  v_add_u32 v154, 1032, v154
  s_cbranch_scc0 K2_M0
  s_branch K2_PRI1
K2_MS0:
  v_exp_f32 v120, v56
  v_exp_f32 v121, v57
  v_exp_f32 v122, v58
  v_exp_f32 v123, v59
  v_exp_f32 v124, v60
  v_exp_f32 v125, v61
  v_exp_f32 v126, v62
  v_exp_f32 v127, v63
  v_exp_f32 v128, v64
  v_exp_f32 v129, v65
  v_exp_f32 v130, v66
  v_exp_f32 v131, v67
  v_exp_f32 v132, v68
  v_pk_fma_f32 v[88:89], v[88:89], v[120:121], v[88:89]
  v_pk_fma_f32 v[90:91], v[90:91], v[122:123], v[90:91]
  v_pk_fma_f32 v[92:93], v[92:93], v[124:125], v[92:93]
  v_pk_fma_f32 v[94:95], v[94:95], v[126:127], v[94:95]
  v_pk_fma_f32 v[96:97], v[96:97], v[128:129], v[96:97]
  v_pk_fma_f32 v[98:99], v[98:99], v[130:131], v[98:99]
  v_pk_fma_f32 v[100:101], v[100:101], v[132:133], v[100:101]
  v_pk_fma_f32 v[102:103], v[102:103], v[134:135], v[102:103]
  v_pk_fma_f32 v[88:89], v[56:57], v[104:105], v[88:89]
  v_pk_fma_f32 v[90:91], v[58:59], v[106:107], v[90:91]
  v_pk_fma_f32 v[92:93], v[60:61], v[108:109], v[92:93]
  v_pk_fma_f32 v[94:95], v[62:63], v[110:111], v[94:95]
  v_pk_fma_f32 v[96:97], v[64:65], v[112:113], v[96:97]
  v_pk_fma_f32 v[98:99], v[66:67], v[114:115], v[98:99]
  v_pk_fma_f32 v[100:101], v[68:69], v[116:117], v[100:101]
  v_pk_fma_f32 v[102:103], v[70:71], v[118:119], v[102:103]
  v_pk_fma_f32 v[104:105], v[104:105], v[120:121], v[104:105]
  v_pk_fma_f32 v[106:107], v[106:107], v[122:123], v[106:107]
  v_pk_fma_f32 v[108:109], v[108:109], v[124:125], v[108:109]
  v_pk_fma_f32 v[110:111], v[110:111], v[126:127], v[110:111]
  v_pk_fma_f32 v[112:113], v[112:113], v[128:129], v[112:113]
  v_pk_fma_f32 v[114:115], v[114:115], v[130:131], v[114:115]
  v_pk_fma_f32 v[116:117], v[116:117], v[132:133], v[116:117]
  v_pk_fma_f32 v[118:119], v[118:119], v[134:135], v[118:119]
  s_branch K2_DONEX
K2_MS1:
  v_exp_f32 v120, v72
  v_exp_f32 v121, v73
  v_exp_f32 v122, v74
  v_exp_f32 v123, v75
  v_exp_f32 v124, v76
  v_exp_f32 v125, v77
  v_exp_f32 v126, v78
  v_exp_f32 v127, v79
  v_exp_f32 v128, v80
  v_exp_f32 v129, v81
  v_exp_f32 v130, v82
  v_exp_f32 v131, v83
  v_exp_f32 v132, v84
  v_pk_fma_f32 v[88:89], v[88:89], v[120:121], v[88:89]
  v_pk_fma_f32 v[90:91], v[90:91], v[122:123], v[90:91]
  v_pk_fma_f32 v[92:93], v[92:93], v[124:125], v[92:93]
  v_pk_fma_f32 v[94:95], v[94:95], v[126:127], v[94:95]
  v_pk_fma_f32 v[96:97], v[96:97], v[128:129], v[96:97]
  v_pk_fma_f32 v[98:99], v[98:99], v[130:131], v[98:99]
  v_pk_fma_f32 v[100:101], v[100:101], v[132:133], v[100:101]
  v_pk_fma_f32 v[102:103], v[102:103], v[134:135], v[102:103]
  v_pk_fma_f32 v[88:89], v[72:73], v[104:105], v[88:89]
  v_pk_fma_f32 v[90:91], v[74:75], v[106:107], v[90:91]
  v_pk_fma_f32 v[92:93], v[76:77], v[108:109], v[92:93]
  v_pk_fma_f32 v[94:95], v[78:79], v[110:111], v[94:95]
  v_pk_fma_f32 v[96:97], v[80:81], v[112:113], v[96:97]
  v_pk_fma_f32 v[98:99], v[82:83], v[114:115], v[98:99]
  v_pk_fma_f32 v[100:101], v[84:85], v[116:117], v[100:101]
  v_pk_fma_f32 v[102:103], v[86:87], v[118:119], v[102:103]
  v_pk_fma_f32 v[104:105], v[104:105], v[120:121], v[104:105]
  v_pk_fma_f32 v[106:107], v[106:107], v[122:123], v[106:107]
  v_pk_fma_f32 v[108:109], v[108:109], v[124:125], v[108:109]
  v_pk_fma_f32 v[110:111], v[110:111], v[126:127], v[110:111]
  v_pk_fma_f32 v[112:113], v[112:113], v[128:129], v[112:113]
  v_pk_fma_f32 v[114:115], v[114:115], v[130:131], v[114:115]
  v_pk_fma_f32 v[116:117], v[116:117], v[132:133], v[116:117]
  v_pk_fma_f32 v[118:119], v[118:119], v[134:135], v[118:119]
K2_DONEX:
  s_mov_b64 exec, -1
K2_DONE:
  v_xor_b32 v3, 64, v164
  v_and_b32 v2, 48, v0
  s_add_u32 s64, s75, 49152
  s_mul_i32 s65, s22, 144
  s_add_u32 s65, s65, 13824
  v_add_u32 v165, s65, v2
  v_add_u32 v2, s64, v2
  s_cmp_eq_u32 s73, 0
  s_waitcnt lgkmcnt(0)
  ds_read_b128 v[56:59], v164
  ds_read_b128 v[60:63], v3
  ds_read_b128 v[40:43], v7 offset:0
  ds_read_b128 v[44:47], v7 offset:1024
  ds_read_b128 v[48:51], v7 offset:4096
  ds_read_b128 v[52:55], v7 offset:5120
  s_cselect_b64 exec, -1, 0
  ds_read_b128 v[64:67], v2
  ds_read_b128 v[68:71], v2 offset:64
  s_mov_b64 exec, -1
  ds_read_b128 v[136:139], v7 offset:2048
  ds_read_b128 v[140:143], v7 offset:3072
  ds_read_b128 v[144:147], v7 offset:6144
  ds_read_b128 v[148:151], v7 offset:7168
  v_rcp_f32 v120, v104
  v_rcp_f32 v121, v105
  v_rcp_f32 v122, v106
  v_rcp_f32 v123, v107
  v_rcp_f32 v124, v108
  v_rcp_f32 v125, v109
  v_rcp_f32 v126, v110
  v_rcp_f32 v127, v111
  v_rcp_f32 v128, v112
  v_rcp_f32 v129, v113
  v_rcp_f32 v130, v114
  v_rcp_f32 v131, v115
  v_rcp_f32 v132, v116
  v_rcp_f32 v133, v117
  v_rcp_f32 v134, v118
  v_rcp_f32 v135, v119
  s_waitcnt lgkmcnt(4)
  v_pk_mul_f32 v[120:121], v[88:89], v[120:121]
  v_mfma_f32_16x16x32_bf16 v[8:11], v[56:59], v[40:43], 0
  v_pk_mul_f32 v[122:123], v[90:91], v[122:123]
  v_pk_mul_f32 v[124:125], v[92:93], v[124:125]
  v_pk_mul_f32 v[126:127], v[94:95], v[126:127]
  v_pk_mul_f32 v[128:129], v[96:97], v[128:129]
  v_mfma_f32_16x16x32_bf16 v[12:15], v[56:59], v[48:51], 0
  v_pk_mul_f32 v[130:131], v[98:99], v[130:131]
  v_pk_mul_f32 v[132:133], v[100:101], v[132:133]
  v_pk_mul_f32 v[134:135], v[102:103], v[134:135]
  v_fmac_f32_dpp v120, v120, v161 row_shl:4 row_mask:0xf bank_mask:0xf bound_ctrl:0
  v_mfma_f32_16x16x32_bf16 v[8:11], v[60:63], v[44:47], v[8:11]
  v_fmac_f32_dpp v121, v121, v161 row_shl:4 row_mask:0xf bank_mask:0xf bound_ctrl:0
  v_fmac_f32_dpp v122, v122, v161 row_shl:4 row_mask:0xf bank_mask:0xf bound_ctrl:0
  v_fmac_f32_dpp v123, v123, v161 row_shl:4 row_mask:0xf bank_mask:0xf bound_ctrl:0
  v_fmac_f32_dpp v124, v124, v161 row_shl:4 row_mask:0xf bank_mask:0xf bound_ctrl:0
  v_fmac_f32_dpp v125, v125, v161 row_shl:4 row_mask:0xf bank_mask:0xf bound_ctrl:0
  v_fmac_f32_dpp v126, v126, v161 row_shl:4 row_mask:0xf bank_mask:0xf bound_ctrl:0
  v_fmac_f32_dpp v127, v127, v161 row_shl:4 row_mask:0xf bank_mask:0xf bound_ctrl:0
  v_fmac_f32_dpp v128, v128, v161 row_shl:4 row_mask:0xf bank_mask:0xf bound_ctrl:0
  v_mfma_f32_16x16x32_bf16 v[12:15], v[60:63], v[52:55], v[12:15]
  v_fmac_f32_dpp v129, v129, v161 row_shl:4 row_mask:0xf bank_mask:0xf bound_ctrl:0
  v_fmac_f32_dpp v130, v130, v161 row_shl:4 row_mask:0xf bank_mask:0xf bound_ctrl:0
  v_fmac_f32_dpp v131, v131, v161 row_shl:4 row_mask:0xf bank_mask:0xf bound_ctrl:0
  v_fmac_f32_dpp v132, v132, v161 row_shl:4 row_mask:0xf bank_mask:0xf bound_ctrl:0
  v_fmac_f32_dpp v133, v133, v161 row_shl:4 row_mask:0xf bank_mask:0xf bound_ctrl:0
  v_fmac_f32_dpp v134, v134, v161 row_shl:4 row_mask:0xf bank_mask:0xf bound_ctrl:0
  v_fmac_f32_dpp v135, v135, v161 row_shl:4 row_mask:0xf bank_mask:0xf bound_ctrl:0
  v_cvt_pk_bf16_f32 v72, v120, v121
  v_cvt_pk_bf16_f32 v73, v122, v123
  v_cvt_pk_bf16_f32 v74, v124, v125
  v_cvt_pk_bf16_f32 v75, v126, v127
  v_cvt_pk_bf16_f32 v76, v128, v129
  v_cvt_pk_bf16_f32 v77, v130, v131
  v_cvt_pk_bf16_f32 v78, v132, v133
  v_cvt_pk_bf16_f32 v79, v134, v135
  s_mov_b64 exec, s[58:59]
  ds_write_b128 v160, v[72:75] offset:0
  ds_write_b128 v160, v[76:79] offset:16
  s_mov_b64 exec, -1
  v_pk_mul_f32 v[2:3], v[88:89], v[104:105]
  v_pk_fma_f32 v[2:3], v[90:91], v[106:107], v[2:3]
  v_pk_fma_f32 v[2:3], v[92:93], v[108:109], v[2:3]
  v_pk_fma_f32 v[2:3], v[94:95], v[110:111], v[2:3]
  v_pk_fma_f32 v[2:3], v[96:97], v[112:113], v[2:3]
  v_pk_fma_f32 v[2:3], v[98:99], v[114:115], v[2:3]
  v_pk_fma_f32 v[2:3], v[100:101], v[116:117], v[2:3]
  v_pk_fma_f32 v[2:3], v[102:103], v[118:119], v[2:3]
  s_movk_i32 s64, 0x207
  v_add_f32 v2, v2, v3
  v_cmp_class_f32 vcc, v2, s64
  v_mov_b32 v2, 0
  s_cbranch_vccz K2_NF
  ds_write_b32 v2, v5 offset:47044
K2_NF:
  s_cbranch_scc0 K2_N3
  v_mfma_f32_16x16x32_bf16 v[16:19], v[64:67], v[40:43], 0
  v_mfma_f32_16x16x32_bf16 v[20:23], v[64:67], v[48:51], 0
  v_mfma_f32_16x16x32_bf16 v[16:19], v[68:71], v[44:47], v[16:19]
  v_mfma_f32_16x16x32_bf16 v[20:23], v[68:71], v[52:55], v[20:23]
K2_N3:
  s_waitcnt lgkmcnt(0)
  s_barrier
K2_EPI:
  ds_read_b128 v[56:59], v163 offset:0
  ds_read_b128 v[60:63], v163 offset:64
  ds_read_b32 v3, v2 offset:47044
  s_cmp_eq_u32 s73, 0
  s_cselect_b64 exec, -1, 0
  ds_read_b128 v[64:67], v165
  ds_read_b128 v[68:71], v165 offset:64
  s_mov_b64 exec, -1
  s_waitcnt lgkmcnt(4)
  v_mfma_f32_16x16x32_bf16 v[120:123], v[56:59], v[136:139], v[8:11]
  v_mfma_f32_16x16x32_bf16 v[124:127], v[56:59], v[144:147], v[12:15]
  s_waitcnt lgkmcnt(3)
  v_mfma_f32_16x16x32_bf16 v[120:123], v[60:63], v[140:143], v[120:123]
  v_mfma_f32_16x16x32_bf16 v[124:127], v[60:63], v[148:151], v[124:127]
  s_cbranch_scc0 K2_N4
  s_waitcnt lgkmcnt(0)
  v_mfma_f32_16x16x32_bf16 v[128:131], v[64:67], v[136:139], v[16:19]
  v_mfma_f32_16x16x32_bf16 v[132:135], v[64:67], v[144:147], v[20:23]
  v_mfma_f32_16x16x32_bf16 v[128:131], v[68:71], v[140:143], v[128:131]
  v_mfma_f32_16x16x32_bf16 v[132:135], v[68:71], v[148:151], v[132:135]
K2_N4:
  s_waitcnt lgkmcnt(2)
  v_readfirstlane_b32 s23, v3
  s_andn2_b32 s23, s23, s71
  s_cbranch_scc1 K2_BF
  s_nop 1
  v_exp_f32 v88, v120
  v_exp_f32 v89, v121
  v_exp_f32 v90, v124
  v_exp_f32 v91, v125
  v_pk_fma_f32 v[88:89], v[88:89], s[66:67], s[66:67]
  v_pk_fma_f32 v[90:91], v[90:91], s[66:67], s[66:67]
  v_rcp_f32 v88, v88
  v_rcp_f32 v89, v89
  v_rcp_f32 v90, v90
  v_rcp_f32 v91, v91
  v_pk_mul_f32 v[88:89], v[88:89], v[120:121]
  v_pk_mul_f32 v[90:91], v[90:91], v[124:125]
  v_cvt_pk_bf16_f32 v88, v88, v90
  v_cvt_pk_bf16_f32 v89, v89, v91
  buffer_store_dword v88, v162, s[36:39], s74 offen offset:0 sc1
  buffer_store_dword v89, v162, s[36:39], s74 offen offset:128 sc1
  v_exp_f32 v92, v122
  v_exp_f32 v93, v123
  v_exp_f32 v94, v126
  v_exp_f32 v95, v127
  v_pk_fma_f32 v[92:93], v[92:93], s[66:67], s[66:67]
  v_pk_fma_f32 v[94:95], v[94:95], s[66:67], s[66:67]
  v_rcp_f32 v92, v92
  v_rcp_f32 v93, v93
  v_rcp_f32 v94, v94
  v_rcp_f32 v95, v95
  v_pk_mul_f32 v[92:93], v[92:93], v[122:123]
  v_pk_mul_f32 v[94:95], v[94:95], v[126:127]
  v_cvt_pk_bf16_f32 v92, v92, v94
  v_cvt_pk_bf16_f32 v93, v93, v95
  buffer_store_dword v92, v162, s[36:39], s74 offen offset:256 sc1
  buffer_store_dword v93, v162, s[36:39], s74 offen offset:384 sc1
  s_cmp_lg_u32 s73, 0
  s_cbranch_scc1 K2_FIN
  s_mov_b64 exec, 0xffff
  v_exp_f32 v96, v128
  v_exp_f32 v97, v132
  s_nop 0
  v_pk_fma_f32 v[96:97], v[96:97], s[66:67], s[66:67]
  v_rcp_f32 v96, v96
  v_rcp_f32 v97, v97
  v_mul_f32 v96, v96, v128
  v_mul_f32 v97, v97, v132
  v_cvt_pk_bf16_f32 v96, v96, v97
  buffer_store_dword v96, v162, s[36:39], s75 offen sc1
K2_FIN:
K2_END:
  s_endpgm
K2_G0R:
  v_mov_b32 v124, v123
  buffer_load_dwordx4 v[24:27], v[124:125], s[28:31], 0 idxen offen
  buffer_load_dwordx4 v[28:31], v[124:125], s[28:31], 0 idxen offen offset:64
  s_branch K2_G0D
K2_DONE0:
  s_waitcnt vmcnt(0) lgkmcnt(0)
  s_branch K2_DONE
K2_MARK:
  s_mov_b64 exec, vcc
  v_mov_b32 v72, 0
  v_mov_b32 v73, 1
  ds_add_rtn_u32 v72, v72, v73 offset:47040
  s_waitcnt lgkmcnt(0)
  v_and_b32 v72, 255, v72
  v_lshlrev_b32 v72, 2, v72
  ds_write_b32 v72, v0 offset:48128
  s_mov_b64 exec, -1
  s_branch K2_MR
K2_RESCAN:
  s_mov_b32 s40, s10
  s_mov_b32 s41, s11
  s_mov_b32 s42, 3200000
  s_mov_b32 s43, 0x20000
  s_mov_b32 s44, s8
  s_mov_b32 s45, s9
  s_mov_b32 s46, 3200000
  s_mov_b32 s47, 0x20000
  s_mov_b32 s48, s6
  s_mov_b32 s49, s7
  s_mov_b32 s50, 1600000
  s_mov_b32 s51, 0x20000
  s_mov_b32 s52, 0
  s_mul_i32 s53, s76, 98
  s_min_u32 s23, s23, 256
  s_waitcnt lgkmcnt(0)
K2_RS1:
  s_lshl_b32 s54, s52, 2
  v_mov_b32 v80, s54
  ds_read_b32 v80, v80 offset:48128
  s_waitcnt lgkmcnt(0)
  v_readfirstlane_b32 s54, v80
  s_and_b32 s55, s54, 31
  s_lshl_b32 s55, s55, 3
  s_lshr_b32 s54, s54, 5
  s_add_u32 s54, s54, s55
  s_mul_i32 s54, s54, 3128
  s_sub_u32 s55, 800000, s54
  s_min_u32 s55, s55, 3128
  v_mov_b32 v80, v0
K2_RS2:
  v_add_u32 v81, s54, v80
  v_lshlrev_b32 v82, 1, v81
  v_lshlrev_b32 v81, 2, v81
  buffer_load_dword v83, v81, s[40:43], 0 offen
  buffer_load_dword v84, v81, s[44:47], 0 offen
  buffer_load_ushort v85, v82, s[48:51], 0 offen
  s_waitcnt vmcnt(0)
  v_subrev_u32 v83, s53, v83
  v_cmp_gt_u32 vcc, 98, v83
  v_cmp_gt_u32 s[56:57], s55, v80
  s_and_b64 exec, vcc, s[56:57]
  v_lshlrev_b32 v83, 2, v83
  ds_add_rtn_u32 v83, v83, v5 offset:46592
  v_lshl_or_b32 v84, v85, 16, v84
  s_waitcnt lgkmcnt(0)
  v_min_u32 v83, s65, v83
  ds_write_b32 v83, v84
  s_mov_b64 exec, -1
  v_add_u32 v80, 768, v80
  v_cmp_gt_u32 vcc, s55, v80
  s_cbranch_vccnz K2_RS2
  s_add_u32 s52, s52, 1
  s_cmp_lt_u32 s52, s23
  s_cbranch_scc1 K2_RS1
  s_mov_b32 s68, -1
  s_waitcnt lgkmcnt(0)
  s_barrier
  s_cmp_eq_u32 s73, 0
  s_cbranch_scc1 K2_AB1T
  s_branch K2_AB1
K2_BF:
  s_waitcnt vmcnt(0) lgkmcnt(0)
  s_mov_b32 s40, s10
  s_mov_b32 s41, s11
  s_mov_b32 s42, 3200000
  s_mov_b32 s43, 0x20000
  s_mov_b32 s44, s8
  s_mov_b32 s45, s9
  s_mov_b32 s46, 3200000
  s_mov_b32 s47, 0x20000
  s_mov_b32 s48, s6
  s_mov_b32 s49, s7
  s_mov_b32 s50, 1600000
  s_mov_b32 s51, 0x20000
  s_mov_b32 s52, s12
  s_mov_b32 s53, s13
  s_mov_b32 s54, 16512
  s_mov_b32 s55, 0x20000
  s_mov_b32 s32, s28
  s_and_b32 s33, s29, 0xffff
  s_mov_b32 s34, 3200000
  s_mov_b32 s35, 0x20000
  v_mov_b32 v56, 0
  v_mov_b32 v57, 0
  v_mov_b32 v58, 0
  v_mov_b32 v59, 0
  v_lshlrev_b32 v60, 4, v0
  v_add_u32 v60, 89088, v60
  ds_write_b128 v60, v[56:59] offset:0
  ds_write_b128 v60, v[56:59] offset:12288
  ds_write_b128 v60, v[56:59] offset:24576
  v_and_b32 v60, 63, v0
  v_lshlrev_b32 v61, 2, v60
  v_lshlrev_b32 v62, 1, v60
  v_and_b32 v63, 8, v60
  v_lshlrev_b32 v63, 3, v63
  v_and_b32 v56, 48, v60
  v_add_u32 v63, v63, v56
  v_and_b32 v56, 7, v60
  v_lshl_add_u32 v63, v56, 1, v63
  s_movk_i32 s56, 16384
  buffer_load_ushort v64, v62, s[52:55], s56 offen
  s_waitcnt vmcnt(0) lgkmcnt(0)
  v_lshlrev_b32 v64, 16, v64
  v_mul_f32 v64, s66, v64
  s_mul_i32 s57, s76, 98
  s_mov_b32 s56, s3
  s_barrier
K2_BF1:
  s_lshl_b32 s58, s56, 8
  s_lshl_b32 s59, s56, 7
  buffer_load_dword v65, v61, s[40:43], s58 offen
  s_waitcnt vmcnt(0)
  v_subrev_u32 v65, s57, v65
  v_cmp_gt_u32 vcc, 98, v65
  s_cbranch_vccz K2_BF3
  buffer_load_dword v66, v61, s[44:47], s58 offen
  buffer_load_ushort v67, v62, s[48:51], s59 offen
  s_mov_b64 s[60:61], vcc
  s_waitcnt vmcnt(0)
K2_BF2:
  s_ff1_i32_b64 s58, s[60:61]
  s_bitset0_b64 s[60:61], s58
  v_readlane_b32 s59, v66, s58
  v_readlane_b32 s62, v65, s58
  v_readlane_b32 s63, v67, s58
  s_min_u32 s59, s59, 24999
  s_lshl_b32 s59, s59, 7
  s_nop 0
  buffer_load_ushort v56, v63, s[32:35], s59 offen
  s_mul_i32 s58, s62, 272
  v_add_u32 v57, s58, v61
  ds_read_b32 v57, v57 offset:16128
  s_lshl_b32 s63, s63, 16
  s_lshl_b32 s62, s62, 8
  s_add_u32 s62, s62, 89088
  v_add_u32 v58, s62, v61
  s_waitcnt vmcnt(0) lgkmcnt(0)
  v_lshlrev_b32 v56, 16, v56
  v_add_f32 v56, v56, v57
  v_fma_f32 v56, s63, v64, v56
  v_exp_f32 v57, v56
  s_nop 0
  v_add_f32 v57, 1.0, v57
  v_rcp_f32 v57, v57
  s_nop 0
  v_mul_f32 v56, v56, v57
  ds_add_f32 v58, v56
  s_cmp_lg_u64 s[60:61], 0
  s_cbranch_scc1 K2_BF2
K2_BF3:
  s_add_u32 s56, s56, 12
  s_cmp_lt_u32 s56, 12500
  s_cbranch_scc1 K2_BF1
  s_waitcnt lgkmcnt(0)
  s_barrier
  v_mov_b32 v60, v0
K2_BF4:
  v_lshlrev_b32 v61, 3, v60
  v_add_u32 v61, 89088, v61
  ds_read_b64 v[56:57], v61
  v_lshrrev_b32 v61, 5, v60
  v_mul_u32_u24 v61, 144, v61
  v_and_b32 v62, 31, v60
  v_lshl_add_u32 v61, v62, 2, v61
  s_waitcnt lgkmcnt(0)
  v_cvt_pk_bf16_f32 v56, v56, v57
  ds_write_b32 v61, v56 offset:0
  v_add_u32 v60, 768, v60
  v_cmpx_gt_u32 vcc, 3136, v60
  s_cbranch_execnz K2_BF4
  s_mov_b64 exec, -1
  s_mov_b32 s71, -1
  s_waitcnt lgkmcnt(0)
  s_barrier
  s_branch K2_EPI
.section .rodata,"a"
.p2align 6
.amdhsa_kernel mpnn_bin_kernel
  .amdhsa_next_free_vgpr 128
  .amdhsa_next_free_sgpr 102
  .amdhsa_accum_offset 128
  .amdhsa_group_segment_fixed_size 0
  .amdhsa_kernarg_size 72
  .amdhsa_user_sgpr_count 2
  .amdhsa_user_sgpr_kernarg_segment_ptr 1
  .amdhsa_system_sgpr_workgroup_id_x 1
.end_amdhsa_kernel
.p2align 6
.amdhsa_kernel mpnn_msg_kernel
  .amdhsa_next_free_vgpr 168
  .amdhsa_next_free_sgpr 102
  .amdhsa_accum_offset 168
  .amdhsa_group_segment_fixed_size 0
  .amdhsa_kernarg_size 72
  .amdhsa_user_sgpr_count 2
  .amdhsa_user_sgpr_kernarg_segment_ptr 1
  .amdhsa_system_sgpr_workgroup_id_x 1
.end_amdhsa_kernel
```
